```python
import torch

def _softmax(x, axis=-1):
    return torch.softmax(x, dim=axis)
def _gelu(x):
    return torch.nn.functional.gelu(x, approximate="tanh")
def _silu(x):
    return torch.nn.functional.silu(x)
def _sigmoid(x):
    return torch.sigmoid(x)
def _layernorm(x, axis=-1, eps=1e-5):
    m = x.mean(dim=axis, keepdim=True)
    v = x.var(dim=axis, keepdim=True, unbiased=False)
    return (x - m) / torch.sqrt(v + eps)
def _scatter_add(tgt, idx, src, axis=0):
    return tgt.clone().index_add_(axis, idx, src)
def _segment_sum(src, seg, n):
    out = torch.zeros((n,) + src.shape[1:], dtype=src.dtype)
    return out.index_add_(0, seg, src)
def _pad(x, pw):
    flat = tuple(v for pair in reversed(pw) for v in pair)
    return torch.nn.functional.pad(x, flat)

kernel_name = 'recurrent_scan__ssm_conv_h3__mixer_channel_mlp__prompt'

def setup_inputs():

    _w = (lambda a: (lambda t: t.to(torch.bfloat16) if t.is_floating_point() else t)(torch.as_tensor(a)))
    def _A_setup():
        B, S, D = 1, 2048, 512
        ks = 4
        return {
            "q": _w((lambda *s: torch.randn(*s, dtype=torch.bfloat16) * 0.05)(B, S, D)),
            "k": _w((lambda *s: torch.randn(*s, dtype=torch.bfloat16) * 0.8)(B, S, D)),
            "v": _w((lambda *s: torch.randn(*s, dtype=torch.bfloat16) * 0.8)(B, S, D)),
            "shift_k": _w((lambda *s: torch.randn(*s, dtype=torch.bfloat16) * 0.8)(D, ks) * 0.5),
            "ssm_k": _w((lambda *s: torch.randn(*s, dtype=torch.bfloat16) * 0.8)(D, S) * (1.0 / S ** 0.5)),
            "ssm_D": _w((lambda *s: torch.randn(*s, dtype=torch.bfloat16) * 0.8)(D)),
        }
    _A_in = _A_setup()

    def _B_setup():
        B, S, D, F = 1, 2048, 512, 1792
        return {
            "x": _w((lambda *s: torch.randn(*s, dtype=torch.bfloat16) * 0.05)(B, S, D)),
            "w1": _w((lambda *s: torch.randn(*s, dtype=torch.bfloat16) * 0.8)(D, F) * (D ** -0.5)),
            "b1": _w((lambda *s: torch.randn(*s, dtype=torch.bfloat16) * 0.4)(F)),
            "w2": _w((lambda *s: torch.randn(*s, dtype=torch.bfloat16) * 0.2)(F, D) * (F ** -0.5)),
            "b2": _w((lambda *s: torch.randn(*s, dtype=torch.bfloat16) * 0.2)(D)),
        }
    _B_in = _B_setup()

    return {
        "A_q": _A_in["q"],
        "A_k": _A_in["k"],
        "A_v": _A_in["v"],
        "A_shift_k": _A_in["shift_k"],
        "A_ssm_k": _A_in["ssm_k"],
        "A_ssm_D": _A_in["ssm_D"],
        "B_x": _B_in["x"],
        "B_w1": _B_in["w1"],
        "B_b1": _B_in["b1"],
        "B_w2": _B_in["w2"],
        "B_b2": _B_in["b2"],
    }

def reference(A_q, A_k, A_v, A_shift_k, A_ssm_k, A_ssm_D, B_x, B_w1, B_b1, B_w2, B_b2):
    def _A_ref(q, k, v, shift_k, ssm_k, ssm_D):
        B, S, D = q.shape
        ks = shift_k.shape[-1]
        k_pad = _pad(k, ((0, 0), (ks - 1, 0), (0, 0)))
        k_shift = torch.zeros_like(k)
        for t in range(ks):
            k_shift = k_shift + k_pad[:, t:t + S, :] * shift_k[:, ks - 1 - t][None, None, :]
        kv = k_shift * v
        L = 2 * S
        kv_pad = _pad(kv, ((0, 0), (0, S), (0, 0)))
        kf_pad = _pad(ssm_k, ((0, 0), (0, S)))
        kv_f = (lambda x, axes=(-2,-1): torch.fft.rfft2(x.float(), dim=axes))(kv_pad[:, None, :, :], axes=(1, 2))
        kf_f = (lambda x, axes=(-2,-1): torch.fft.rfft2(x.float(), dim=axes))(kf_pad[:, None, :], axes=(1, 2))
        kf_f = (lambda x, *d: x.permute(*d))(kf_f, 1, 2, 0)
        y_f = kv_f * kf_f[None, :, :, :]
        y = (lambda x, s, axes=(-2,-1): torch.fft.irfft2(x, s=s, dim=axes).to(torch.bfloat16))(y_f, (1, L), axes=(1, 2))[:, 0, :S, :]
        y = y + kv * ssm_D[None, None, :]
        return q * y

    def _B_ref(x, w1, b1, w2, b2):
        y = _layernorm(x, axis=-1)
        h = _gelu(torch.einsum("bsd,df->bsf", y, w1) + b1)
        return torch.einsum("bsf,fd->bsd", h, w2) + b2

    x = A_q
    xn = _layernorm(x, axis=-1)
    s = _A_ref(xn, A_k, A_v, A_shift_k, A_ssm_k, A_ssm_D)
    g = _silu(_B_ref(xn, B_w1, B_b1, B_w2, B_b2))
    return x + s * g
```

```asm
; @launch grid=(256,1,1) block=(512,1,1) lds=163840
.amdgcn_target "amdgcn-amd-amdhsa--gfx950"
.text
.globl recurrent_scan__ssm_conv_h3__mixer_channel_mlp__prompt_kernel
.p2align 8
.type recurrent_scan__ssm_conv_h3__mixer_channel_mlp__prompt_kernel,@function
recurrent_scan__ssm_conv_h3__mixer_channel_mlp__prompt_kernel:
    s_cmp_ge_u32 s2, 256
    s_cbranch_scc1 L_end
    s_load_dwordx16 s[64:79], s[0:1], 0
    s_load_dwordx8 s[80:87], s[0:1], 64
    s_load_dwordx4 s[88:91], s[0:1], 96
    s_getpc_b64 s[92:93]
L_pc:
    v_and_b32 v1, 63, v0
    v_lshrrev_b32 v3, 6, v0
    v_lshlrev_b32 v14, 4, v0
    v_readfirstlane_b32 s48, v3
    s_mov_b32 s94, L_code_end-L_pc
    s_mov_b32 s95, 0x20000
    s_and_b32 s49, s2, 7
    s_lshr_b32 s50, s2, 3
    s_mov_b32 s51, 0xffff0000
    s_mov_b32 s6, 20971520
    s_mov_b32 s7, 0x20000
    s_mov_b32 s10, 2097152
    s_mov_b32 s11, 0x20000
    s_mov_b32 s14, 2097152
    s_mov_b32 s15, 0x20000
    s_mov_b32 s18, 2097152
    s_mov_b32 s19, 0x20000
    s_mov_b32 s22, 4096
    s_mov_b32 s23, 0x20000
    s_mov_b32 s26, 2097152
    s_mov_b32 s27, 0x20000
    s_mov_b32 s30, 1835008
    s_mov_b32 s31, 0x20000
    s_mov_b32 s34, 1835008
    s_mov_b32 s35, 0x20000
    s_mov_b32 s38, 2097152
    s_mov_b32 s39, 0x20000
    s_mov_b32 s42, 3584
    s_mov_b32 s43, 0x20000
    s_mov_b32 s46, 1024
    s_mov_b32 s47, 0x20000
    s_min_u32 s3, s50, 27
    s_cmp_lt_u32 s50, 28
    s_cselect_b32 s60, -1, 0
    s_lshr_b32 s55, s49, 1
    s_lshl_b32 s55, s55, 2
    s_and_b32 s57, s3, 3
    s_add_u32 s55, s55, s57
    s_and_b32 s56, s49, 1
    s_mul_i32 s56, s56, 7
    s_lshr_b32 s3, s3, 2
    s_add_u32 s56, s56, s3
    s_lshl_b32 s57, s57, 1
    s_add_u32 s57, s57, s3
    s_mov_b32 s57, s49
    s_and_b32 s58, s48, 3
    s_lshr_b32 s59, s48, 2
    s_lshl_b32 s61, s49, 2
    s_and_b32 s3, s50, 3
    s_add_u32 s61, s61, s3
    s_lshr_b32 s62, s50, 2
    v_and_b32 v3, 31, v1
    v_lshrrev_b32 v4, 5, v1
    v_lshlrev_b32 v13, 4, v1
    v_mov_b32 v16, 0
    v_lshlrev_b32 v17, 2, v1
    v_add_u32 v17, 141056, v17
    ds_write_b32 v17, v16
    s_cmp_eq_u32 s59, 0
    s_cbranch_scc1 L_cpath
    v_lshrrev_b32 v16, 3, v1
    v_and_b32 v17, 7, v1
    v_lshrrev_b32 v18, 4, v1
    s_lshl_b32 s3, s55, 7
    s_lshl_b32 s63, s58, 5
    s_add_u32 s3, s3, s63
    v_add_u32 v19, s3, v16
    v_lshlrev_b32 v19, 10, v19
    v_xor_b32 v20, v17, v18
    v_lshlrev_b32 v20, 4, v20
    v_add_u32 v10, v19, v20
    v_add_u32 v20, 4, v18
    v_xor_b32 v20, v17, v20
    v_lshlrev_b32 v20, 4, v20
    v_add_u32 v11, v19, v20
    v_add_u32 v11, 8192, v11
    v_and_b32 v21, 15, v1
    v_lshlrev_b32 v20, 2, v18
    v_xor_b32 v21, v21, v20
    v_lshlrev_b32 v21, 4, v21
    s_lshl_b32 s3, s58, 4
    v_add_u32 v19, s3, v18
    v_mul_u32_u24 v19, 3584, v19
    v_add_u32 v12, v19, v21
    s_lshl_b32 s3, s56, 8
    v_add_u32 v12, s3, v12
    s_lshl_b32 s98, s58, 12
    v_mov_b32 v31, 141056
    s_lshl_b32 s3, s58, 2
    v_add_u32 v30, s3, v31
    s_waitcnt lgkmcnt(0)
    s_barrier
    s_mov_b64 s[8:9], s[64:65]
    s_mov_b64 s[28:29], s[78:79]
    s_mov_b64 s[32:33], s[82:83]
    s_cmp_eq_u32 s60, 0
    s_cbranch_scc1 L_idle_1
    s_add_u32 s99, s57, 0
    s_and_b32 s99, s99, 7
    s_lshl_b32 s100, s99, 7
    s_mul_i32 s101, s99, 229376
    s_add_u32 m0, s98, 0
    s_nop 0
    buffer_load_dwordx4 v10, s[8:11], s100 offen lds
    s_add_u32 m0, s98, 16384
    s_nop 0
    buffer_load_dwordx4 v12, s[28:31], s101 offen lds
    s_add_u32 s101, s101, 14336
    s_add_u32 m0, s98, 1024
    s_nop 0
    buffer_load_dwordx4 v11, s[8:11], s100 offen lds
    s_add_u32 s100, s100, 16384
    s_add_u32 m0, s98, 17408
    s_nop 0
    buffer_load_dwordx4 v12, s[28:31], s101 offen lds
    s_add_u32 s101, s101, 14336
    s_add_u32 m0, s98, 2048
    s_nop 0
    buffer_load_dwordx4 v10, s[8:11], s100 offen lds
    s_add_u32 m0, s98, 18432
    s_nop 0
    buffer_load_dwordx4 v12, s[28:31], s101 offen lds
    s_add_u32 s101, s101, 14336
    s_add_u32 m0, s98, 3072
    s_nop 0
    buffer_load_dwordx4 v11, s[8:11], s100 offen lds
    s_add_u32 s100, s100, 16384
    s_add_u32 m0, s98, 19456
    s_nop 0
    buffer_load_dwordx4 v12, s[28:31], s101 offen lds
    s_add_u32 s101, s101, 14336
    s_add_u32 s99, s57, 1
    s_and_b32 s99, s99, 7
    s_lshl_b32 s100, s99, 7
    s_mul_i32 s101, s99, 229376
    s_add_u32 m0, s98, 32768
    s_nop 0
    buffer_load_dwordx4 v10, s[8:11], s100 offen lds
    s_add_u32 m0, s98, 49152
    s_nop 0
    buffer_load_dwordx4 v12, s[28:31], s101 offen lds
    s_add_u32 s101, s101, 14336
    s_add_u32 m0, s98, 33792
    s_nop 0
    buffer_load_dwordx4 v11, s[8:11], s100 offen lds
    s_add_u32 s100, s100, 16384
    s_add_u32 m0, s98, 50176
    s_nop 0
    buffer_load_dwordx4 v12, s[28:31], s101 offen lds
    s_add_u32 s101, s101, 14336
    s_add_u32 m0, s98, 34816
    s_nop 0
    buffer_load_dwordx4 v10, s[8:11], s100 offen lds
    s_add_u32 m0, s98, 51200
    s_nop 0
    buffer_load_dwordx4 v12, s[28:31], s101 offen lds
    s_add_u32 s101, s101, 14336
    s_add_u32 m0, s98, 35840
    s_nop 0
    buffer_load_dwordx4 v11, s[8:11], s100 offen lds
    s_add_u32 s100, s100, 16384
    s_add_u32 m0, s98, 52224
    s_nop 0
    buffer_load_dwordx4 v12, s[28:31], s101 offen lds
    s_add_u32 s101, s101, 14336
    s_branch L_act_2
L_idle_1:
    s_lshl_b32 s99, s49, 2
    s_add_u32 s99, s99, s50
    s_sub_u32 s99, s99, 28
    s_lshl_b32 s99, s99, 2
    s_add_u32 s99, s99, s58
    s_lshr_b32 s100, s99, 4
    s_and_b32 s101, s99, 15
    s_mul_i32 s3, s101, 7*16384
    s_lshl_b32 s63, s100, 7
    s_add_u32 s3, s3, s63
    v_lshlrev_b32 v5, 2, v3
    v_lshlrev_b32 v6, 12, v4
    v_add_u32_e64 v5, v5, v6
    buffer_load_dword v132, v5, s[32:35], s3 offen offset:0
    buffer_load_dword v136, v5, s[32:35], s3 offen offset:1024
    buffer_load_dword v133, v5, s[32:35], s3 offen offset:2048
    buffer_load_dword v137, v5, s[32:35], s3 offen offset:3072
    s_add_u32 s3, s3, 8192
    buffer_load_dword v134, v5, s[32:35], s3 offen offset:0
    buffer_load_dword v138, v5, s[32:35], s3 offen offset:1024
    buffer_load_dword v135, v5, s[32:35], s3 offen offset:2048
    buffer_load_dword v139, v5, s[32:35], s3 offen offset:3072
    s_add_u32 s3, s3, 8192
    buffer_load_dword v140, v5, s[32:35], s3 offen offset:0
    buffer_load_dword v144, v5, s[32:35], s3 offen offset:1024
    buffer_load_dword v141, v5, s[32:35], s3 offen offset:2048
    buffer_load_dword v145, v5, s[32:35], s3 offen offset:3072
    s_add_u32 s3, s3, 8192
    buffer_load_dword v142, v5, s[32:35], s3 offen offset:0
    buffer_load_dword v146, v5, s[32:35], s3 offen offset:1024
    buffer_load_dword v143, v5, s[32:35], s3 offen offset:2048
    buffer_load_dword v147, v5, s[32:35], s3 offen offset:3072
    s_add_u32 s3, s3, 8192
    buffer_load_dword v148, v5, s[32:35], s3 offen offset:0
    buffer_load_dword v152, v5, s[32:35], s3 offen offset:1024
    buffer_load_dword v149, v5, s[32:35], s3 offen offset:2048
    buffer_load_dword v153, v5, s[32:35], s3 offen offset:3072
    s_add_u32 s3, s3, 8192
    buffer_load_dword v150, v5, s[32:35], s3 offen offset:0
    buffer_load_dword v154, v5, s[32:35], s3 offen offset:1024
    buffer_load_dword v151, v5, s[32:35], s3 offen offset:2048
    buffer_load_dword v155, v5, s[32:35], s3 offen offset:3072
    s_add_u32 s3, s3, 8192
    buffer_load_dword v156, v5, s[32:35], s3 offen offset:0
    buffer_load_dword v160, v5, s[32:35], s3 offen offset:1024
    buffer_load_dword v157, v5, s[32:35], s3 offen offset:2048
    buffer_load_dword v161, v5, s[32:35], s3 offen offset:3072
    s_add_u32 s3, s3, 8192
    buffer_load_dword v158, v5, s[32:35], s3 offen offset:0
    buffer_load_dword v162, v5, s[32:35], s3 offen offset:1024
    buffer_load_dword v159, v5, s[32:35], s3 offen offset:2048
    buffer_load_dword v163, v5, s[32:35], s3 offen offset:3072
    s_add_u32 s3, s3, 8192
    buffer_load_dword v164, v5, s[32:35], s3 offen offset:0
    buffer_load_dword v168, v5, s[32:35], s3 offen offset:1024
    buffer_load_dword v165, v5, s[32:35], s3 offen offset:2048
    buffer_load_dword v169, v5, s[32:35], s3 offen offset:3072
    s_add_u32 s3, s3, 8192
    buffer_load_dword v166, v5, s[32:35], s3 offen offset:0
    buffer_load_dword v170, v5, s[32:35], s3 offen offset:1024
    buffer_load_dword v167, v5, s[32:35], s3 offen offset:2048
    buffer_load_dword v171, v5, s[32:35], s3 offen offset:3072
    s_add_u32 s3, s3, 8192
    buffer_load_dword v172, v5, s[32:35], s3 offen offset:0
    buffer_load_dword v176, v5, s[32:35], s3 offen offset:1024
    buffer_load_dword v173, v5, s[32:35], s3 offen offset:2048
    buffer_load_dword v177, v5, s[32:35], s3 offen offset:3072
    s_add_u32 s3, s3, 8192
    buffer_load_dword v174, v5, s[32:35], s3 offen offset:0
    buffer_load_dword v178, v5, s[32:35], s3 offen offset:1024
    buffer_load_dword v175, v5, s[32:35], s3 offen offset:2048
    buffer_load_dword v179, v5, s[32:35], s3 offen offset:3072
    s_add_u32 s3, s3, 8192
    buffer_load_dword v180, v5, s[32:35], s3 offen offset:0
    buffer_load_dword v184, v5, s[32:35], s3 offen offset:1024
    buffer_load_dword v181, v5, s[32:35], s3 offen offset:2048
    buffer_load_dword v185, v5, s[32:35], s3 offen offset:3072
    s_add_u32 s3, s3, 8192
    buffer_load_dword v182, v5, s[32:35], s3 offen offset:0
    buffer_load_dword v186, v5, s[32:35], s3 offen offset:1024
    buffer_load_dword v183, v5, s[32:35], s3 offen offset:2048
    buffer_load_dword v187, v5, s[32:35], s3 offen offset:3072
    s_add_u32 s3, s3, 8192
L_act_2:
    s_mov_b64 s[8:9], s[64:65]
    s_mov_b64 s[28:29], s[78:79]
    s_mov_b64 s[4:5], s[90:91]
    s_mov_b64 s[12:13], s[66:67]
    s_mov_b64 s[16:17], s[68:69]
    s_mov_b64 s[20:21], s[70:71]
    s_mov_b64 s[24:25], s[72:73]
    s_mov_b64 s[32:33], s[82:83]
    s_mov_b64 s[36:37], s[86:87]
    s_mov_b64 s[40:41], s[80:81]
    s_mov_b64 s[44:45], s[84:85]
    s_mov_b32 s88, 4325376
    s_load_dword s52, s[4:5], s88
    s_lshl_b32 s87, s2, 2
    s_load_dword s54, s[74:75], s87
    s_mul_i32 s79, s58, 12
    s_add_u32 s79, s79, 64
    s_mul_i32 s63, s62, 112
    s_add_u32 s63, s63, s79
    s_lshl_b32 s63, s63, 11
    s_add_u32 s63, s63, 12582912
    s_lshl_b32 s66, s62, 1
    s_sub_u32 s3, s66, 12
    s_cmp_ge_u32 s66, 12
    s_cselect_b32 s66, s3, s66
    s_and_b32 s69, s62, 1
    v_lshlrev_b32 v35, 5, v1
    s_lshl_b32 s65, s2, 3
    s_lshl_b32 s3, s58, 1
    s_add_u32 s65, s65, s3
    s_waitcnt lgkmcnt(0)
    s_mul_i32 s52, s52, 1664525
    s_add_u32 s52, s52, 1013904223
    s_xor_b32 s53, s52, 0x5bd1e995
    s_cmp_lg_u32 s60, 0
    s_cbranch_scc1 L_nw2_3
    s_mov_b32 s84, 0x05040100
    s_mov_b32 s85, 0x07060302
    s_mul_i32 s64, s100, 112
    s_mul_i32 s3, s101, 7
    s_add_u32 s64, s64, s3
    s_lshl_b32 s64, s64, 11
    s_add_u32 s64, s64, 12582912
    s_waitcnt vmcnt(48)
    v_perm_b32 v128, v136, v132, s84
    v_perm_b32 v129, v137, v133, s84
    v_perm_b32 v130, v138, v134, s84
    v_perm_b32 v131, v139, v135, s84
    v_perm_b32 v132, v136, v132, s85
    v_perm_b32 v133, v137, v133, s85
    v_perm_b32 v134, v138, v134, s85
    v_perm_b32 v135, v139, v135, s85
    buffer_store_dwordx4 v[128:131], v13, s[4:7], s64 offen sc1
    buffer_store_dwordx4 v[132:135], v13, s[4:7], s64 offen offset:1024 sc1
    s_add_u32 s64, s64, 2048
    s_waitcnt vmcnt(42)
    s_nop 0
    v_perm_b32 v136, v144, v140, s84
    v_perm_b32 v137, v145, v141, s84
    v_perm_b32 v138, v146, v142, s84
    v_perm_b32 v139, v147, v143, s84
    v_perm_b32 v140, v144, v140, s85
    v_perm_b32 v141, v145, v141, s85
    v_perm_b32 v142, v146, v142, s85
    v_perm_b32 v143, v147, v143, s85
    buffer_store_dwordx4 v[136:139], v13, s[4:7], s64 offen sc1
    buffer_store_dwordx4 v[140:143], v13, s[4:7], s64 offen offset:1024 sc1
    s_add_u32 s64, s64, 2048
    s_waitcnt vmcnt(36)
    s_nop 0
    v_perm_b32 v144, v152, v148, s84
    v_perm_b32 v145, v153, v149, s84
    v_perm_b32 v146, v154, v150, s84
    v_perm_b32 v147, v155, v151, s84
    v_perm_b32 v148, v152, v148, s85
    v_perm_b32 v149, v153, v149, s85
    v_perm_b32 v150, v154, v150, s85
    v_perm_b32 v151, v155, v151, s85
    buffer_store_dwordx4 v[144:147], v13, s[4:7], s64 offen sc1
    buffer_store_dwordx4 v[148:151], v13, s[4:7], s64 offen offset:1024 sc1
    s_add_u32 s64, s64, 2048
    s_waitcnt vmcnt(30)
    s_nop 0
    v_perm_b32 v152, v160, v156, s84
    v_perm_b32 v153, v161, v157, s84
    v_perm_b32 v154, v162, v158, s84
    v_perm_b32 v155, v163, v159, s84
    v_perm_b32 v156, v160, v156, s85
    v_perm_b32 v157, v161, v157, s85
    v_perm_b32 v158, v162, v158, s85
    v_perm_b32 v159, v163, v159, s85
    buffer_store_dwordx4 v[152:155], v13, s[4:7], s64 offen sc1
    buffer_store_dwordx4 v[156:159], v13, s[4:7], s64 offen offset:1024 sc1
    s_add_u32 s64, s64, 2048
    s_waitcnt vmcnt(24)
    s_nop 0
    v_perm_b32 v160, v168, v164, s84
    v_perm_b32 v161, v169, v165, s84
    v_perm_b32 v162, v170, v166, s84
    v_perm_b32 v163, v171, v167, s84
    v_perm_b32 v164, v168, v164, s85
    v_perm_b32 v165, v169, v165, s85
    v_perm_b32 v166, v170, v166, s85
    v_perm_b32 v167, v171, v167, s85
    buffer_store_dwordx4 v[160:163], v13, s[4:7], s64 offen sc1
    buffer_store_dwordx4 v[164:167], v13, s[4:7], s64 offen offset:1024 sc1
    s_add_u32 s64, s64, 2048
    s_waitcnt vmcnt(18)
    s_nop 0
    v_perm_b32 v168, v176, v172, s84
    v_perm_b32 v169, v177, v173, s84
    v_perm_b32 v170, v178, v174, s84
    v_perm_b32 v171, v179, v175, s84
    v_perm_b32 v172, v176, v172, s85
    v_perm_b32 v173, v177, v173, s85
    v_perm_b32 v174, v178, v174, s85
    v_perm_b32 v175, v179, v175, s85
    buffer_store_dwordx4 v[168:171], v13, s[4:7], s64 offen sc1
    buffer_store_dwordx4 v[172:175], v13, s[4:7], s64 offen offset:1024 sc1
    s_add_u32 s64, s64, 2048
    s_waitcnt vmcnt(12)
    s_nop 0
    v_perm_b32 v176, v184, v180, s84
    v_perm_b32 v177, v185, v181, s84
    v_perm_b32 v178, v186, v182, s84
    v_perm_b32 v179, v187, v183, s84
    v_perm_b32 v180, v184, v180, s85
    v_perm_b32 v181, v185, v181, s85
    v_perm_b32 v182, v186, v182, s85
    v_perm_b32 v183, v187, v183, s85
    buffer_store_dwordx4 v[176:179], v13, s[4:7], s64 offen sc1
    buffer_store_dwordx4 v[180:183], v13, s[4:7], s64 offen offset:1024 sc1
    s_add_u32 s64, s64, 2048
    s_lshl_b32 s64, s99, 3
    s_add_u32 s64, s64, 4390912
    s_waitcnt vmcnt(0)
    v_mov_b32 v36, s52
    v_mov_b32 v37, s53
    v_mov_b32 v38, 0
    s_mov_b64 exec, 1
    buffer_store_dwordx2 v[36:37], v38, s[4:7], s64 offen sc1
    s_mov_b64 exec, -1
    s_mov_b32 s87, 0
    s_branch L_hearly
L_nw2_3:
    s_waitcnt vmcnt(8)
    v_mov_b32 v154, 1
    s_mov_b64 exec, 1
    ds_write_b32 v30, v154
    s_mov_b64 exec, -1
    s_add_u32 s99, s57, 2
    s_and_b32 s99, s99, 7
    s_lshl_b32 s100, s99, 7
    s_mul_i32 s101, s99, 229376
    s_add_u32 m0, s98, 65536
    s_nop 0
    buffer_load_dwordx4 v10, s[8:11], s100 offen lds
    s_add_u32 m0, s98, 81920
    s_nop 0
    buffer_load_dwordx4 v12, s[28:31], s101 offen lds
    s_add_u32 s101, s101, 14336
    s_add_u32 m0, s98, 66560
    s_nop 0
    buffer_load_dwordx4 v11, s[8:11], s100 offen lds
    s_add_u32 s100, s100, 16384
    s_add_u32 m0, s98, 82944
    s_nop 0
    buffer_load_dwordx4 v12, s[28:31], s101 offen lds
    s_add_u32 s101, s101, 14336
    s_add_u32 m0, s98, 67584
    s_nop 0
    buffer_load_dwordx4 v10, s[8:11], s100 offen lds
    s_add_u32 m0, s98, 83968
    s_nop 0
    buffer_load_dwordx4 v12, s[28:31], s101 offen lds
    s_add_u32 s101, s101, 14336
    s_add_u32 m0, s98, 68608
    s_nop 0
    buffer_load_dwordx4 v11, s[8:11], s100 offen lds
    s_add_u32 s100, s100, 16384
    s_add_u32 m0, s98, 84992
    s_nop 0
    buffer_load_dwordx4 v12, s[28:31], s101 offen lds
    s_add_u32 s101, s101, 14336
    s_waitcnt vmcnt(8)
    v_mov_b32 v154, 2
    s_mov_b64 exec, 1
    ds_write_b32 v30, v154
    s_mov_b64 exec, -1
    s_add_u32 s99, s57, 3
    s_and_b32 s99, s99, 7
    s_lshl_b32 s100, s99, 7
    s_mul_i32 s101, s99, 229376
    s_add_u32 m0, s98, 98304
    s_nop 0
    buffer_load_dwordx4 v10, s[8:11], s100 offen lds
    s_add_u32 m0, s98, 114688
    s_nop 0
    buffer_load_dwordx4 v12, s[28:31], s101 offen lds
    s_add_u32 s101, s101, 14336
    s_add_u32 m0, s98, 99328
    s_nop 0
    buffer_load_dwordx4 v11, s[8:11], s100 offen lds
    s_add_u32 s100, s100, 16384
    s_add_u32 m0, s98, 115712
    s_nop 0
    buffer_load_dwordx4 v12, s[28:31], s101 offen lds
    s_add_u32 s101, s101, 14336
    s_add_u32 m0, s98, 100352
    s_nop 0
    buffer_load_dwordx4 v10, s[8:11], s100 offen lds
    s_add_u32 m0, s98, 116736
    s_nop 0
    buffer_load_dwordx4 v12, s[28:31], s101 offen lds
    s_add_u32 s101, s101, 14336
    s_add_u32 m0, s98, 101376
    s_nop 0
    buffer_load_dwordx4 v11, s[8:11], s100 offen lds
    s_add_u32 s100, s100, 16384
    s_add_u32 m0, s98, 117760
    s_nop 0
    buffer_load_dwordx4 v12, s[28:31], s101 offen lds
    s_add_u32 s101, s101, 14336
    s_lshl_b32 s3, s65, 10
    buffer_load_dwordx4 v[40:43], v35, s[8:11], s3 offen
    buffer_load_dwordx4 v[44:47], v35, s[8:11], s3 offen offset:16
    v_min_u32 v9, 15, v1
    v_lshlrev_b32 v9, 3, v9
    s_lshl_b32 s77, s62, 7
    s_add_u32 s77, s77, 4390912
    s_lshl_b32 s80, s66, 11
    s_add_u32 s80, s80, s63
    s_add_u32 s81, s63, 24576
    s_mov_b32 s87, -1
    s_waitcnt vmcnt(10)
    v_mov_b32 v154, 3
    s_mov_b64 exec, 1
    ds_write_b32 v30, v154
    s_mov_b64 exec, -1
    s_mov_b32 s3, 0
L_fs_4:
    ds_read_b128 v[24:27], v31 offset:16
    s_waitcnt lgkmcnt(0)
    v_min3_u32 v24, v24, v25, v26
    v_min_u32 v24, v24, v27
    v_cmp_gt_u32 vcc, 1, v24
    s_cbranch_vccz L_fo_5
    s_add_u32 s3, s3, 1
    s_cmp_gt_u32 s3, 400000
    s_cbranch_scc1 L_fo_5
    s_sleep 1
    s_branch L_fs_4
L_fo_5:
    s_add_u32 s99, s57, 4
    s_and_b32 s99, s99, 7
    s_lshl_b32 s100, s99, 7
    s_mul_i32 s101, s99, 229376
    s_add_u32 m0, s98, 0
    s_nop 0
    buffer_load_dwordx4 v10, s[8:11], s100 offen lds
    s_add_u32 m0, s98, 16384
    s_nop 0
    buffer_load_dwordx4 v12, s[28:31], s101 offen lds
    s_add_u32 s101, s101, 14336
    s_add_u32 m0, s98, 1024
    s_nop 0
    buffer_load_dwordx4 v11, s[8:11], s100 offen lds
    s_add_u32 s100, s100, 16384
    s_add_u32 m0, s98, 17408
    s_nop 0
    buffer_load_dwordx4 v12, s[28:31], s101 offen lds
    s_add_u32 s101, s101, 14336
    s_add_u32 m0, s98, 2048
    s_nop 0
    buffer_load_dwordx4 v10, s[8:11], s100 offen lds
    s_add_u32 m0, s98, 18432
    s_nop 0
    buffer_load_dwordx4 v12, s[28:31], s101 offen lds
    s_add_u32 s101, s101, 14336
    s_add_u32 m0, s98, 3072
    s_nop 0
    buffer_load_dwordx4 v11, s[8:11], s100 offen lds
    s_add_u32 s100, s100, 16384
    s_add_u32 m0, s98, 19456
    s_nop 0
    buffer_load_dwordx4 v12, s[28:31], s101 offen lds
    s_add_u32 s101, s101, 14336
    s_waitcnt vmcnt(8)
    v_lshlrev_b32 v96, 16, v40
    v_and_b32 v97, s51, v40
    v_lshlrev_b32 v98, 16, v41
    v_and_b32 v99, s51, v41
    v_lshlrev_b32 v100, 16, v42
    v_and_b32 v101, s51, v42
    v_lshlrev_b32 v102, 16, v43
    v_and_b32 v103, s51, v43
    v_lshlrev_b32 v104, 16, v44
    v_and_b32 v105, s51, v44
    v_lshlrev_b32 v106, 16, v45
    v_and_b32 v107, s51, v45
    v_lshlrev_b32 v108, 16, v46
    v_and_b32 v109, s51, v46
    v_lshlrev_b32 v110, 16, v47
    v_and_b32 v111, s51, v47
    v_add_f32 v112, v96, v100
    v_add_f32 v113, v97, v101
    v_add_f32 v114, v98, v102
    v_add_f32 v115, v99, v103
    v_add_f32 v112, v112, v104
    v_add_f32 v113, v113, v105
    v_add_f32 v114, v114, v106
    v_add_f32 v115, v115, v107
    v_add_f32 v112, v112, v108
    v_add_f32 v113, v113, v109
    v_add_f32 v114, v114, v110
    v_add_f32 v115, v115, v111
    v_add_f32 v112, v112, v113
    v_add_f32 v114, v114, v115
    v_add_f32 v112, v112, v114
    s_nop 1
    v_add_f32_dpp v112, v112, v112 row_shr:1 row_mask:0xf bank_mask:0xf bound_ctrl:0
    s_nop 1
    v_add_f32_dpp v112, v112, v112 row_shr:2 row_mask:0xf bank_mask:0xf bound_ctrl:0
    s_nop 1
    v_add_f32_dpp v112, v112, v112 row_shr:4 row_mask:0xf bank_mask:0xf bound_ctrl:0
    s_nop 1
    v_add_f32_dpp v112, v112, v112 row_shr:8 row_mask:0xf bank_mask:0xf bound_ctrl:0
    s_nop 1
    v_add_f32_dpp v112, v112, v112 row_bcast:15 row_mask:0xa bank_mask:0xf
    s_nop 0
    v_readlane_b32 s82, v112, 31
    v_readlane_b32 s83, v112, 63
    s_nop 0
    v_mov_b32 v112, s82
    s_mov_b32 exec_lo, 0
    v_mov_b32 v112, s83
    s_mov_b32 exec_lo, -1
    v_mul_f32 v116, 0x3b000000, v112
    v_sub_f32 v96, v96, v116
    v_sub_f32 v97, v97, v116
    v_sub_f32 v98, v98, v116
    v_sub_f32 v99, v99, v116
    v_sub_f32 v100, v100, v116
    v_sub_f32 v101, v101, v116
    v_sub_f32 v102, v102, v116
    v_sub_f32 v103, v103, v116
    v_sub_f32 v104, v104, v116
    v_sub_f32 v105, v105, v116
    v_sub_f32 v106, v106, v116
    v_sub_f32 v107, v107, v116
    v_sub_f32 v108, v108, v116
    v_sub_f32 v109, v109, v116
    v_sub_f32 v110, v110, v116
    v_sub_f32 v111, v111, v116
    v_mul_f32 v112, v96, v96
    v_mul_f32 v113, v97, v97
    v_mul_f32 v114, v98, v98
    v_mul_f32 v115, v99, v99
    s_waitcnt vmcnt(10)
    v_mov_b32 v154, 4
    s_mov_b64 exec, 1
    ds_write_b32 v30, v154
    s_mov_b64 exec, -1
    s_mov_b32 s3, 0
L_fs_6:
    ds_read_b128 v[24:27], v31 offset:16
    s_waitcnt lgkmcnt(0)
    v_min3_u32 v24, v24, v25, v26
    v_min_u32 v24, v24, v27
    v_cmp_gt_u32 vcc, 2, v24
    s_cbranch_vccz L_fo_7
    s_add_u32 s3, s3, 1
    s_cmp_gt_u32 s3, 400000
    s_cbranch_scc1 L_fo_7
    s_sleep 1
    s_branch L_fs_6
L_fo_7:
    s_add_u32 s99, s57, 5
    s_and_b32 s99, s99, 7
    s_lshl_b32 s100, s99, 7
    s_mul_i32 s101, s99, 229376
    s_add_u32 m0, s98, 32768
    s_nop 0
    buffer_load_dwordx4 v10, s[8:11], s100 offen lds
    s_add_u32 m0, s98, 49152
    s_nop 0
    buffer_load_dwordx4 v12, s[28:31], s101 offen lds
    s_add_u32 s101, s101, 14336
    s_add_u32 m0, s98, 33792
    s_nop 0
    buffer_load_dwordx4 v11, s[8:11], s100 offen lds
    s_add_u32 s100, s100, 16384
    s_add_u32 m0, s98, 50176
    s_nop 0
    buffer_load_dwordx4 v12, s[28:31], s101 offen lds
    s_add_u32 s101, s101, 14336
    s_add_u32 m0, s98, 34816
    s_nop 0
    buffer_load_dwordx4 v10, s[8:11], s100 offen lds
    s_add_u32 m0, s98, 51200
    s_nop 0
    buffer_load_dwordx4 v12, s[28:31], s101 offen lds
    s_add_u32 s101, s101, 14336
    s_add_u32 m0, s98, 35840
    s_nop 0
    buffer_load_dwordx4 v11, s[8:11], s100 offen lds
    s_add_u32 s100, s100, 16384
    s_add_u32 m0, s98, 52224
    s_nop 0
    buffer_load_dwordx4 v12, s[28:31], s101 offen lds
    s_add_u32 s101, s101, 14336
    v_fmac_f32 v112, v100, v100
    v_fmac_f32 v113, v101, v101
    v_fmac_f32 v114, v102, v102
    v_fmac_f32 v115, v103, v103
    v_fmac_f32 v112, v104, v104
    v_fmac_f32 v113, v105, v105
    v_fmac_f32 v114, v106, v106
    v_fmac_f32 v115, v107, v107
    v_fmac_f32 v112, v108, v108
    v_fmac_f32 v113, v109, v109
    v_fmac_f32 v114, v110, v110
    v_fmac_f32 v115, v111, v111
    v_add_f32 v112, v112, v113
    v_add_f32 v114, v114, v115
    v_add_f32 v112, v112, v114
    s_nop 1
    v_add_f32_dpp v112, v112, v112 row_shr:1 row_mask:0xf bank_mask:0xf bound_ctrl:0
    s_nop 1
    v_add_f32_dpp v112, v112, v112 row_shr:2 row_mask:0xf bank_mask:0xf bound_ctrl:0
    s_nop 1
    v_add_f32_dpp v112, v112, v112 row_shr:4 row_mask:0xf bank_mask:0xf bound_ctrl:0
    s_nop 1
    v_add_f32_dpp v112, v112, v112 row_shr:8 row_mask:0xf bank_mask:0xf bound_ctrl:0
    s_nop 1
    v_add_f32_dpp v112, v112, v112 row_bcast:15 row_mask:0xa bank_mask:0xf
    s_nop 0
    v_readlane_b32 s82, v112, 31
    v_readlane_b32 s83, v112, 63
    s_nop 0
    v_mov_b32 v112, s82
    s_mov_b32 exec_lo, 0
    v_mov_b32 v112, s83
    s_mov_b32 exec_lo, -1
    v_mul_f32 v117, 0x3b000000, v112
    v_cvt_pk_bf16_f32 v100, v116, v116
    v_lshlrev_b32 v100, 16, v100
    v_cvt_pk_bf16_f32 v118, v117, v117
    v_lshlrev_b32 v118, 16, v118
    v_add_f32 v118, 0x3727c5ac, v118
    v_cvt_pk_bf16_f32 v118, v118, v118
    v_lshlrev_b32 v118, 16, v118
    v_sqrt_f32 v118, v118
    s_nop 0
    v_cvt_pk_bf16_f32 v118, v118, v118
    v_lshlrev_b32 v118, 16, v118
    v_rcp_f32 v102, v118
    v_sub_f32 v119, v116, v100
    v_mul_f32 v120, v117, v102
    v_mul_f32 v119, v119, v102
    v_mul_f32 v120, v120, v102
    v_cvt_pk_bf16_f32 v119, v119, v119
    v_lshlrev_b32 v119, 16, v119
    v_cvt_pk_bf16_f32 v120, v120, v120
    v_lshlrev_b32 v120, 16, v120
    v_add_f32 v120, 0x3727c5ac, v120
    v_cvt_pk_bf16_f32 v120, v120, v120
    v_lshlrev_b32 v120, 16, v120
    v_sqrt_f32 v120, v120
    s_nop 0
    v_cvt_pk_bf16_f32 v120, v120, v120
    v_lshlrev_b32 v120, 16, v120
    v_rcp_f32 v120, v120
    v_fma_f32 v98, v100, v102, v119
    v_mov_b32 v97, s52
    v_mov_b32 v99, s53
    v_mov_b32 v101, s52
    v_mov_b32 v103, s53
    v_lshlrev_b32 v35, 5, v4
    v_mul_f32 v96, v102, v120
    v_mul_f32 v98, v98, v120
    v_sub_f32 v98, 0, v98
    s_lshl_b32 s64, s65, 5
    s_add_u32 s64, s64, 4194304
    s_mov_b32 exec_lo, 1
    s_mov_b32 exec_hi, 1
    buffer_store_dwordx4 v[96:99], v35, s[4:7], s64 offen sc1
    buffer_store_dwordx4 v[100:103], v35, s[4:7], s64 offen offset:16 sc1
    s_mov_b64 exec, -1
    s_waitcnt vmcnt(10)
    v_mov_b32 v154, 5
    s_mov_b64 exec, 1
    ds_write_b32 v30, v154
    s_mov_b64 exec, -1
    s_mov_b32 s3, 0
L_fs_8:
    ds_read_b128 v[24:27], v31 offset:16
    s_waitcnt lgkmcnt(0)
    v_min3_u32 v24, v24, v25, v26
    v_min_u32 v24, v24, v27
    v_cmp_gt_u32 vcc, 3, v24
    s_cbranch_vccz L_fo_9
    s_add_u32 s3, s3, 1
    s_cmp_gt_u32 s3, 400000
    s_cbranch_scc1 L_fo_9
    s_sleep 1
    s_branch L_fs_8
L_fo_9:
    s_add_u32 s99, s57, 6
    s_and_b32 s99, s99, 7
    s_lshl_b32 s100, s99, 7
    s_mul_i32 s101, s99, 229376
    s_add_u32 m0, s98, 65536
    s_nop 0
    buffer_load_dwordx4 v10, s[8:11], s100 offen lds
    s_add_u32 m0, s98, 81920
    s_nop 0
    buffer_load_dwordx4 v12, s[28:31], s101 offen lds
    s_add_u32 s101, s101, 14336
    s_add_u32 m0, s98, 66560
    s_nop 0
    buffer_load_dwordx4 v11, s[8:11], s100 offen lds
    s_add_u32 s100, s100, 16384
    s_add_u32 m0, s98, 82944
    s_nop 0
    buffer_load_dwordx4 v12, s[28:31], s101 offen lds
    s_add_u32 s101, s101, 14336
    s_add_u32 m0, s98, 67584
    s_nop 0
    buffer_load_dwordx4 v10, s[8:11], s100 offen lds
    s_add_u32 m0, s98, 83968
    s_nop 0
    buffer_load_dwordx4 v12, s[28:31], s101 offen lds
    s_add_u32 s101, s101, 14336
    s_add_u32 m0, s98, 68608
    s_nop 0
    buffer_load_dwordx4 v11, s[8:11], s100 offen lds
    s_add_u32 s100, s100, 16384
    s_add_u32 m0, s98, 84992
    s_nop 0
    buffer_load_dwordx4 v12, s[28:31], s101 offen lds
    s_add_u32 s101, s101, 14336
    s_waitcnt vmcnt(10)
    v_mov_b32 v154, 6
    s_mov_b64 exec, 1
    ds_write_b32 v30, v154
    s_mov_b64 exec, -1
    s_mov_b32 s3, 0
L_fs_10:
    ds_read_b128 v[24:27], v31 offset:16
    s_waitcnt lgkmcnt(0)
    v_min3_u32 v24, v24, v25, v26
    v_min_u32 v24, v24, v27
    v_cmp_gt_u32 vcc, 4, v24
    s_cbranch_vccz L_fo_11
    s_add_u32 s3, s3, 1
    s_cmp_gt_u32 s3, 400000
    s_cbranch_scc1 L_fo_11
    s_sleep 1
    s_branch L_fs_10
L_fo_11:
    s_add_u32 s99, s57, 7
    s_and_b32 s99, s99, 7
    s_lshl_b32 s100, s99, 7
    s_mul_i32 s101, s99, 229376
    s_add_u32 m0, s98, 98304
    s_nop 0
    buffer_load_dwordx4 v10, s[8:11], s100 offen lds
    s_add_u32 m0, s98, 114688
    s_nop 0
    buffer_load_dwordx4 v12, s[28:31], s101 offen lds
    s_add_u32 s101, s101, 14336
    s_add_u32 m0, s98, 99328
    s_nop 0
    buffer_load_dwordx4 v11, s[8:11], s100 offen lds
    s_add_u32 s100, s100, 16384
    s_add_u32 m0, s98, 115712
    s_nop 0
    buffer_load_dwordx4 v12, s[28:31], s101 offen lds
    s_add_u32 s101, s101, 14336
    s_add_u32 m0, s98, 100352
    s_nop 0
    buffer_load_dwordx4 v10, s[8:11], s100 offen lds
    s_add_u32 m0, s98, 116736
    s_nop 0
    buffer_load_dwordx4 v12, s[28:31], s101 offen lds
    s_add_u32 s101, s101, 14336
    s_add_u32 m0, s98, 101376
    s_nop 0
    buffer_load_dwordx4 v11, s[8:11], s100 offen lds
    s_add_u32 s100, s100, 16384
    s_add_u32 m0, s98, 117760
    s_nop 0
    buffer_load_dwordx4 v12, s[28:31], s101 offen lds
    s_add_u32 s101, s101, 14336
    s_waitcnt vmcnt(8)
    v_mov_b32 v154, 7
    s_mov_b64 exec, 1
    ds_write_b32 v30, v154
    s_mov_b64 exec, -1
L_hearly:
    s_lshr_b32 s70, s58, 1
    s_and_b32 s71, s58, 1
    s_mul_i32 s74, s70, 4608
    s_add_u32 s74, s74, 141312
    v_and_b32 v5, 15, v1
    v_lshrrev_b32 v6, 4, v1
    v_lshlrev_b32 v7, 3, v6
    v_add3_u32 v7, v7, v5, 1
    v_and_b32 v8, 3, v7
    v_mul_u32_u24 v8, 4160, v8
    v_and_b32 v7, 0x3c, v7
    v_lshlrev_b32 v7, 1, v7
    v_add_u32 v7, v7, v8
    s_mul_i32 s76, s70, 16640
    s_lshl_b32 s77, s71, 8
    s_add_u32 s76, s76, s77
    s_add_u32 s76, s76, 0
    v_add_u32 v144, s76, v7
    v_lshlrev_b32 v7, 4, v6
    v_lshlrev_b32 v8, 5, v5
    v_sub_u32 v7, v7, v8
    s_add_u32 s76, s74, s77
    s_add_u32 s76, s76, 480
    v_add_u32 v145, s76, v7
    v_and_b32 v7, 1, v6
    v_lshrrev_b32 v8, 1, v6
    v_lshlrev_b32 v8, 3, v8
    v_or_b32 v7, v7, v8
    v_xor_b32 v7, v7, v5
    v_lshlrev_b32 v8, 4, v6
    v_add_u32 v7, v7, v8
    v_lshlrev_b32 v7, 4, v7
    s_lshl_b32 s76, s58, 13
    s_add_u32 s76, s76, 65536
    v_add_u32 v146, s76, v7
    v_lshrrev_b32 v5, 2, v1
    v_and_b32 v6, 3, v1
    v_and_b32 v7, 1, v6
    v_lshrrev_b32 v8, 1, v6
    v_lshlrev_b32 v8, 3, v8
    v_or_b32 v7, v7, v8
    v_xor_b32 v7, v7, v5
    v_lshlrev_b32 v8, 4, v6
    v_add_u32 v7, v7, v8
    v_lshlrev_b32 v7, 4, v7
    s_lshl_b32 s76, s58, 11
    s_add_u32 s76, s76, 65536
    v_add_u32 v147, s76, v7
    s_lshl_b32 s76, s58, 10
    s_sub_u32 s76, 144888, s76
    v_lshlrev_b32 v8, 3, v1
    v_sub_u32 v148, s76, v8
    v_add_u32 v149, 0xfffff000, v14
    v_and_b32 v24, 7, v3
    s_lshl_b32 s84, s58, 13
    s_add_u32 s84, s84, 65536
    v_add_u32 v25, 0, v4
    v_xor_b32 v25, v25, v24
    v_lshl_add_u32 v25, v3, 3, v25
    v_lshlrev_b32 v25, 4, v25
    v_add_u32 v14, s84, v25
    v_add_u32 v25, 2, v4
    v_xor_b32 v25, v25, v24
    v_lshl_add_u32 v25, v3, 3, v25
    v_lshlrev_b32 v25, 4, v25
    v_add_u32 v15, s84, v25
    v_add_u32 v25, 4, v4
    v_xor_b32 v25, v25, v24
    v_lshl_add_u32 v25, v3, 3, v25
    v_lshlrev_b32 v25, 4, v25
    v_add_u32 v16, s84, v25
    v_add_u32 v25, 6, v4
    v_xor_b32 v25, v25, v24
    v_lshl_add_u32 v25, v3, 3, v25
    v_lshlrev_b32 v25, 4, v25
    v_add_u32 v17, s84, v25
    v_lshrrev_b32 v24, 3, v0
    v_and_b32 v25, 7, v0
    v_lshlrev_b32 v21, 10, v24
    v_lshlrev_b32 v22, 4, v25
    v_add_u32 v21, v21, v22
    v_lshlrev_b32 v23, 5, v24
    v_and_b32 v18, 7, v24
    v_xor_b32 v18, v18, v25
    v_and_b32 v26, 31, v24
    v_lshl_add_u32 v18, v26, 3, v18
    v_lshlrev_b32 v18, 4, v18
    v_lshrrev_b32 v26, 5, v24
    v_xor_b32 v26, s69, v26
    v_xor_b32 v26, 1, v26
    v_lshlrev_b32 v26, 16, v26
    v_add_u32 v18, v18, v26
    v_lshlrev_b32 v19, 16, v25
    v_lshrrev_b32 v26, 2, v24
    v_lshlrev_b32 v26, 4, v26
    v_add_u32 v19, v19, v26
    v_and_b32 v26, 2, v24
    v_lshlrev_b32 v26, 9, v26
    v_add_u32 v19, v19, v26
    v_and_b32 v20, 1, v24
L_hpost:
    v_min_u32 v9, 15, v1
    v_lshlrev_b32 v9, 3, v9
    s_lshl_b32 s77, s62, 7
    s_add_u32 s77, s77, 4390912
    s_lshr_b32 s78, s2, 3
    s_lshl_b32 s78, s78, 8
    s_add_u32 s78, s78, 4329472
    v_lshlrev_b32 v151, 3, v3
    s_waitcnt vmcnt(0)
    v_mov_b32 v154, 8
    s_mov_b64 exec, 1
    ds_write_b32 v30, v154
    s_mov_b64 exec, -1
    s_cmp_lg_u32 s48, 4
    s_cbranch_scc1 L_np_12
    s_mov_b32 s3, 0
L_spin_13:
    buffer_load_dwordx2 v[152:153], v151, s[4:7], s78 offen sc1
    s_waitcnt vmcnt(0)
    v_xor_b32 v152, s52, v152
    v_xor_b32 v153, s53, v153
    v_or_b32 v152, v152, v153
    v_cmp_ne_u32 vcc, 0, v152
    s_cbranch_vccz L_ok_14
    s_add_u32 s3, s3, 1
    s_cmp_gt_u32 s3, 20000
    s_cbranch_scc1 L_ok_14
    s_sleep 12
    s_branch L_spin_13
L_ok_14:
    v_mov_b32 v152, 1
    s_mov_b64 exec, 1
    ds_write_b32 v31, v152 offset:116
    s_mov_b64 exec, -1
L_np_12:
    s_cmp_lg_u32 s48, 5
    s_cbranch_scc1 L_np_15
    s_mov_b32 s3, 0
L_spin_16:
    buffer_load_dwordx2 v[24:25], v9, s[4:7], s77 offen sc1
    s_waitcnt vmcnt(0)
    v_xor_b32 v24, s52, v24
    v_xor_b32 v25, s53, v25
    v_or_b32 v24, v24, v25
    v_cmp_ne_u32 vcc, 0, v24
    s_cbranch_vccz L_ok_17
    s_add_u32 s3, s3, 1
    s_cmp_gt_u32 s3, 20000
    s_cbranch_scc1 L_ok_17
    s_sleep 12
    s_branch L_spin_16
L_ok_17:
    v_mov_b32 v24, 1
    s_mov_b64 exec, 1
    ds_write_b32 v31, v24 offset:112
    s_mov_b64 exec, -1
L_np_15:
    s_lshl_b32 s72, s2, 13
    v_mov_b32 v150, 0
    s_add_u32 s73, s72, 0
    s_nop 0
    buffer_load_dwordx4 v[80:83], v149, s[24:27], s73 offen
    buffer_load_dwordx2 v[84:85], v149, s[24:27], s73 offen offset:16
    buffer_load_dwordx2 v[86:87], v150, s[24:27], s73 offen
    s_add_u32 s73, s72, 4096
    buffer_load_dwordx4 v[88:91], v149, s[24:27], s73 offen
    buffer_load_dwordx2 v[92:93], v149, s[24:27], s73 offen offset:16
    buffer_load_dwordx2 v[94:95], v150, s[24:27], s73 offen
    s_mov_b32 s3, 0
L_fs_18:
    ds_read_b128 v[24:27], v31 offset:16
    s_waitcnt lgkmcnt(0)
    v_min3_u32 v24, v24, v25, v26
    v_min_u32 v24, v24, v27
    v_cmp_gt_u32 vcc, 1, v24
    s_cbranch_vccz L_fo_19
    s_add_u32 s3, s3, 1
    s_cmp_gt_u32 s3, 400000
    s_cbranch_scc1 L_fo_19
    s_sleep 4
    s_branch L_fs_18
L_fo_19:
    s_mov_b32 s3, 0
L_ws_20:
    ds_read_b32 v152, v31 offset:116
    s_waitcnt lgkmcnt(0)
    v_cmp_eq_u32 vcc, 0, v152
    s_cbranch_vccz L_wo_21
    s_add_u32 s3, s3, 1
    s_cmp_gt_u32 s3, 400000
    s_cbranch_scc1 L_wo_21
    s_sleep 2
    s_branch L_ws_20
L_wo_21:
    s_lshl_b32 s73, s2, 13
    s_lshl_b32 s3, s58, 10
    s_add_u32 s73, s73, s3
    s_add_u32 s73, s73, 0
    s_add_u32 m0, s3, 141312
    s_add_u32 s72, s73, 4096
    buffer_load_dwordx4 v13, s[4:7], s73 offen sc1 lds
    s_add_u32 m0, s3, 145920
    s_nop 0
    buffer_load_dwordx4 v13, s[4:7], s72 offen sc1 lds
    v_mov_b32 v68, 0
    v_mov_b32 v69, 0
    v_mov_b32 v70, 0
    v_mov_b32 v71, 0
    v_mov_b32 v72, 0
    v_mov_b32 v73, 0
    v_mov_b32 v76, 0
    v_mov_b32 v77, 0
    v_mul_u32_u24 v6, 4608, v4
    v_lshlrev_b32 v155, 4, v3
    v_add_u32 v6, v6, v155
    v_add_u32 v6, 141312, v6
    ds_write_b128 v6, v[68:71] offset:4096
    s_mov_b32 s3, 0
L_ws_22:
    ds_read_b32 v24, v31 offset:112
    s_waitcnt lgkmcnt(0)
    v_cmp_eq_u32 vcc, 0, v24
    s_cbranch_vccz L_wo_23
    s_add_u32 s3, s3, 1
    s_cmp_gt_u32 s3, 400000
    s_cbranch_scc1 L_wo_23
    s_sleep 2
    s_branch L_ws_22
L_wo_23:
    s_cmp_lg_u32 s87, 0
    s_cbranch_scc1 L_redo_24
    s_lshl_b32 s80, s66, 11
    s_add_u32 s80, s80, s63
    s_add_u32 s81, s63, 24576
L_redo_24:
    buffer_load_dwordx4 v[160:163], v13, s[4:7], s80 offen sc1
    buffer_load_dwordx4 v[164:167], v13, s[4:7], s80 offen offset:1024 sc1
    s_add_u32 s80, s80, 2048
    s_cmp_eq_u32 s80, s81
    s_cselect_b32 s80, s63, s80
    buffer_load_dwordx4 v[168:171], v13, s[4:7], s80 offen sc1
    buffer_load_dwordx4 v[172:175], v13, s[4:7], s80 offen offset:1024 sc1
    s_add_u32 s80, s80, 2048
    s_cmp_eq_u32 s80, s81
    s_cselect_b32 s80, s63, s80
    buffer_load_dwordx4 v[176:179], v13, s[4:7], s80 offen sc1
    buffer_load_dwordx4 v[180:183], v13, s[4:7], s80 offen offset:1024 sc1
    s_add_u32 s80, s80, 2048
    s_cmp_eq_u32 s80, s81
    s_cselect_b32 s80, s63, s80
    buffer_load_dwordx4 v[184:187], v13, s[4:7], s80 offen sc1
    buffer_load_dwordx4 v[188:191], v13, s[4:7], s80 offen offset:1024 sc1
    s_add_u32 s80, s80, 2048
    s_cmp_eq_u32 s80, s81
    s_cselect_b32 s80, s63, s80
    buffer_load_dwordx4 v[192:195], v13, s[4:7], s80 offen sc1
    buffer_load_dwordx4 v[196:199], v13, s[4:7], s80 offen offset:1024 sc1
    s_add_u32 s80, s80, 2048
    s_cmp_eq_u32 s80, s81
    s_cselect_b32 s80, s63, s80
    s_mov_b32 s3, 0
L_fs_25:
    ds_read_b128 v[24:27], v31 offset:16
    s_waitcnt lgkmcnt(0)
    v_min3_u32 v24, v24, v25, v26
    v_min_u32 v24, v24, v27
    v_cmp_gt_u32 vcc, 6, v24
    s_cbranch_vccz L_fo_26
    s_add_u32 s3, s3, 1
    s_cmp_gt_u32 s3, 400000
    s_cbranch_scc1 L_fo_26
    s_sleep 2
    s_branch L_fs_25
L_fo_26:
    s_waitcnt vmcnt(12)
    v_alignbit_b32 v96, v81, v80, 16
    v_alignbit_b32 v97, v82, v81, 16
    v_alignbit_b32 v98, v83, v82, 16
    v_alignbit_b32 v99, v84, v83, 16
    v_mov_b32 v100, v81
    v_mov_b32 v101, v82
    v_mov_b32 v102, v83
    v_mov_b32 v103, v84
    v_alignbit_b32 v104, v82, v81, 16
    v_alignbit_b32 v105, v83, v82, 16
    v_alignbit_b32 v106, v84, v83, 16
    v_alignbit_b32 v107, v85, v84, 16
    ds_write_b128 v149, v[80:83] offset:32
    ds_write_b128 v149, v[96:99] offset:4192
    ds_write_b128 v149, v[100:103] offset:8352
    ds_write_b128 v149, v[104:107] offset:12512
    v_alignbit_b32 v108, v89, v88, 16
    v_alignbit_b32 v109, v90, v89, 16
    v_alignbit_b32 v110, v91, v90, 16
    v_alignbit_b32 v111, v92, v91, 16
    v_mov_b32 v112, v89
    v_mov_b32 v113, v90
    v_mov_b32 v114, v91
    v_mov_b32 v115, v92
    v_alignbit_b32 v116, v90, v89, 16
    v_alignbit_b32 v117, v91, v90, 16
    v_alignbit_b32 v118, v92, v91, 16
    v_alignbit_b32 v119, v93, v92, 16
    ds_write_b128 v149, v[88:91] offset:16672
    ds_write_b128 v149, v[108:111] offset:20832
    ds_write_b128 v149, v[112:115] offset:24992
    ds_write_b128 v149, v[116:119] offset:29152
    s_sub_u32 s3, 3, s58
    s_lshl_b32 s3, s3, 4
    s_mul_i32 s78, s58, 4160
    v_mov_b32 v5, s78
    v_lshlrev_b64 v[86:87], 16, v[86:87]
    v_lshlrev_b64 v[94:95], 16, v[94:95]
    v_lshlrev_b64 v[74:75], s3, v[86:87]
    v_lshlrev_b64 v[78:79], s3, v[94:95]
    s_mov_b64 exec, 1
    ds_write_b128 v5, v[68:71] offset:0
    ds_write_b128 v5, v[72:75] offset:16
    ds_write_b128 v5, v[68:71] offset:16640
    ds_write_b128 v5, v[76:79] offset:16656
    s_mov_b64 exec, -1
    s_waitcnt vmcnt(10)
    s_waitcnt lgkmcnt(0)
    v_mov_b32 v5, 1
    s_mov_b64 exec, 1
    ds_write_b32 v30, v5 offset:64
    s_mov_b64 exec, -1
    buffer_load_dwordx4 v[200:203], v13, s[4:7], s80 offen sc1
    buffer_load_dwordx4 v[204:207], v13, s[4:7], s80 offen offset:1024 sc1
    s_add_u32 s80, s80, 2048
    s_cmp_eq_u32 s80, s81
    s_cselect_b32 s80, s63, s80
    buffer_load_dwordx4 v[208:211], v13, s[4:7], s80 offen sc1
    buffer_load_dwordx4 v[212:215], v13, s[4:7], s80 offen offset:1024 sc1
    s_add_u32 s80, s80, 2048
    s_cmp_eq_u32 s80, s81
    s_cselect_b32 s80, s63, s80
    buffer_load_dwordx4 v[216:219], v13, s[4:7], s80 offen sc1
    buffer_load_dwordx4 v[220:223], v13, s[4:7], s80 offen offset:1024 sc1
    s_add_u32 s80, s80, 2048
    s_cmp_eq_u32 s80, s81
    s_cselect_b32 s80, s63, s80
    buffer_load_dwordx4 v[224:227], v13, s[4:7], s80 offen sc1
    buffer_load_dwordx4 v[228:231], v13, s[4:7], s80 offen offset:1024 sc1
    s_add_u32 s80, s80, 2048
    s_cmp_eq_u32 s80, s81
    s_cselect_b32 s80, s63, s80
    buffer_load_dwordx4 v[232:235], v13, s[4:7], s80 offen sc1
    buffer_load_dwordx4 v[236:239], v13, s[4:7], s80 offen offset:1024 sc1
    s_add_u32 s80, s80, 2048
    s_cmp_eq_u32 s80, s81
    s_cselect_b32 s80, s63, s80
    buffer_load_dwordx4 v[240:243], v13, s[4:7], s80 offen sc1
    buffer_load_dwordx4 v[244:247], v13, s[4:7], s80 offen offset:1024 sc1
    s_add_u32 s80, s80, 2048
    s_cmp_eq_u32 s80, s81
    s_cselect_b32 s80, s63, s80
    buffer_load_dwordx4 v[248:251], v13, s[4:7], s80 offen sc1
    buffer_load_dwordx4 v[252:255], v13, s[4:7], s80 offen offset:1024 sc1
    s_add_u32 s80, s80, 2048
    s_cmp_eq_u32 s80, s81
    s_cselect_b32 s80, s63, s80
    s_lshl_b32 s89, s62, 19
    s_lshr_b32 s3, s61, 2
    s_lshl_b32 s3, s3, 11
    s_add_u32 s89, s89, s3
    s_and_b32 s3, s61, 3
    s_lshl_b32 s3, s3, 8
    s_add_u32 s89, s89, s3
    s_add_u32 s89, s89, 16777216
    s_lshl_b32 s86, s61, 16
    s_lshl_b32 s87, s62, 7
    s_add_u32 s86, s86, s87
    s_lshl_b32 s88, s61, 11
    s_add_u32 s88, s88, 4194320
    s_mul_i32 s64, s61, 224
    s_add_u32 s64, s64, s79
    s_mul_i32 s3, s69, 112
    s_add_u32 s64, s64, s3
    s_lshl_b32 s64, s64, 10
    s_add_u32 s64, s64, 5242880
    s_lshl_b32 s65, s66, 10
    s_add_u32 s65, s65, s64
    s_add_u32 s67, s64, 12288
    s_mul_i32 s68, s69, 229376
    s_sub_u32 s68, 114688, s68
    s_mov_b32 s3, 0
L_fs_27:
    ds_read_b128 v[24:27], v31 offset:64
    s_waitcnt lgkmcnt(0)
    v_min3_u32 v24, v24, v25, v26
    v_min_u32 v24, v24, v27
    v_cmp_gt_u32 vcc, 1, v24
    s_cbranch_vccz L_fo_28
    s_add_u32 s3, s3, 1
    s_cmp_gt_u32 s3, 400000
    s_cbranch_scc1 L_fo_28
    s_sleep 1
    s_branch L_fs_27
L_fo_28:
    s_nop 0
    ds_read_b64 v[64:65], v144 offset:0
    ds_read_b64 v[66:67], v144 offset:8
    ds_read_b64 v[68:69], v144 offset:512
    ds_read_b64 v[70:71], v144 offset:520
    ds_read_b64 v[72:73], v144 offset:1024
    ds_read_b64 v[74:75], v144 offset:1032
    ds_read_b64 v[76:77], v144 offset:1536
    ds_read_b64 v[78:79], v144 offset:1544
    ds_read_b64 v[80:81], v144 offset:2048
    ds_read_b64 v[82:83], v144 offset:2056
    ds_read_b64 v[84:85], v144 offset:2560
    ds_read_b64 v[86:87], v144 offset:2568
    ds_read_b64 v[88:89], v144 offset:3072
    ds_read_b64 v[90:91], v144 offset:3080
    ds_read_b64 v[92:93], v144 offset:3584
    ds_read_b64 v[94:95], v144 offset:3592
    ds_read_b128 v[96:99], v145 offset:3584
    ds_read_b128 v[100:103], v145 offset:3072
    ds_read_b128 v[104:107], v145 offset:2560
    ds_read_b128 v[108:111], v145 offset:2048
    ds_read_b128 v[112:115], v145 offset:1536
    ds_read_b128 v[116:119], v145 offset:1024
    ds_read_b128 v[120:123], v145 offset:512
    ds_read_b128 v[124:127], v145 offset:0
    s_mov_b32 s3, 0
L_fs_29:
    ds_read_b128 v[24:27], v31 offset:48
    s_waitcnt lgkmcnt(0)
    v_min3_u32 v24, v24, v25, v26
    v_min_u32 v24, v24, v27
    v_cmp_gt_u32 vcc, 1, v24
    s_cbranch_vccz L_fo_30
    s_add_u32 s3, s3, 1
    s_cmp_gt_u32 s3, 400000
    s_cbranch_scc1 L_fo_30
    s_sleep 2
    s_branch L_fs_29
L_fo_30:
    s_setprio 2
    v_mfma_f32_16x16x32_bf16 v[32:35], v[64:67], v[96:99], 0
    v_mfma_f32_16x16x32_bf16 v[36:39], v[68:71], v[96:99], 0
    v_mfma_f32_16x16x32_bf16 v[40:43], v[72:75], v[96:99], 0
    v_mfma_f32_16x16x32_bf16 v[44:47], v[76:79], v[96:99], 0
    v_mfma_f32_16x16x32_bf16 v[48:51], v[80:83], v[96:99], 0
    v_mfma_f32_16x16x32_bf16 v[52:55], v[84:87], v[96:99], 0
    v_mfma_f32_16x16x32_bf16 v[56:59], v[88:91], v[96:99], 0
    v_mfma_f32_16x16x32_bf16 v[60:63], v[92:95], v[96:99], 0
    v_mfma_f32_16x16x32_bf16 v[36:39], v[64:67], v[100:103], v[36:39]
    v_mfma_f32_16x16x32_bf16 v[40:43], v[68:71], v[100:103], v[40:43]
    v_mfma_f32_16x16x32_bf16 v[44:47], v[72:75], v[100:103], v[44:47]
    v_mfma_f32_16x16x32_bf16 v[48:51], v[76:79], v[100:103], v[48:51]
    v_mfma_f32_16x16x32_bf16 v[52:55], v[80:83], v[100:103], v[52:55]
    v_mfma_f32_16x16x32_bf16 v[56:59], v[84:87], v[100:103], v[56:59]
    v_mfma_f32_16x16x32_bf16 v[60:63], v[88:91], v[100:103], v[60:63]
    ds_read_b128 v[96:99], v145 offset:3648
    ds_read_b64 v[92:93], v144 offset:3648
    ds_read_b64 v[94:95], v144 offset:3656
    v_mfma_f32_16x16x32_bf16 v[40:43], v[64:67], v[104:107], v[40:43]
    v_mfma_f32_16x16x32_bf16 v[44:47], v[68:71], v[104:107], v[44:47]
    v_mfma_f32_16x16x32_bf16 v[48:51], v[72:75], v[104:107], v[48:51]
    v_mfma_f32_16x16x32_bf16 v[52:55], v[76:79], v[104:107], v[52:55]
    v_mfma_f32_16x16x32_bf16 v[56:59], v[80:83], v[104:107], v[56:59]
    v_mfma_f32_16x16x32_bf16 v[60:63], v[84:87], v[104:107], v[60:63]
    ds_read_b128 v[100:103], v145 offset:3136
    ds_read_b64 v[88:89], v144 offset:3136
    ds_read_b64 v[90:91], v144 offset:3144
    v_mfma_f32_16x16x32_bf16 v[44:47], v[64:67], v[108:111], v[44:47]
    v_mfma_f32_16x16x32_bf16 v[48:51], v[68:71], v[108:111], v[48:51]
    v_mfma_f32_16x16x32_bf16 v[52:55], v[72:75], v[108:111], v[52:55]
    v_mfma_f32_16x16x32_bf16 v[56:59], v[76:79], v[108:111], v[56:59]
    v_mfma_f32_16x16x32_bf16 v[60:63], v[80:83], v[108:111], v[60:63]
    ds_read_b128 v[104:107], v145 offset:2624
    ds_read_b64 v[84:85], v144 offset:2624
    ds_read_b64 v[86:87], v144 offset:2632
    v_mfma_f32_16x16x32_bf16 v[48:51], v[64:67], v[112:115], v[48:51]
    v_mfma_f32_16x16x32_bf16 v[52:55], v[68:71], v[112:115], v[52:55]
    v_mfma_f32_16x16x32_bf16 v[56:59], v[72:75], v[112:115], v[56:59]
    v_mfma_f32_16x16x32_bf16 v[60:63], v[76:79], v[112:115], v[60:63]
    ds_read_b128 v[108:111], v145 offset:2112
    ds_read_b64 v[80:81], v144 offset:2112
    ds_read_b64 v[82:83], v144 offset:2120
    v_mfma_f32_16x16x32_bf16 v[52:55], v[64:67], v[116:119], v[52:55]
    v_mfma_f32_16x16x32_bf16 v[56:59], v[68:71], v[116:119], v[56:59]
    v_mfma_f32_16x16x32_bf16 v[60:63], v[72:75], v[116:119], v[60:63]
    ds_read_b128 v[112:115], v145 offset:1600
    ds_read_b64 v[76:77], v144 offset:1600
    ds_read_b64 v[78:79], v144 offset:1608
    v_mfma_f32_16x16x32_bf16 v[56:59], v[64:67], v[120:123], v[56:59]
    v_mfma_f32_16x16x32_bf16 v[60:63], v[68:71], v[120:123], v[60:63]
    ds_read_b128 v[116:119], v145 offset:1088
    ds_read_b64 v[72:73], v144 offset:1088
    ds_read_b64 v[74:75], v144 offset:1096
    v_mfma_f32_16x16x32_bf16 v[60:63], v[64:67], v[124:127], v[60:63]
    ds_read_b128 v[120:123], v145 offset:576
    ds_read_b64 v[68:69], v144 offset:576
    ds_read_b64 v[70:71], v144 offset:584
    ds_read_b128 v[124:127], v145 offset:64
    ds_read_b64 v[64:65], v144 offset:64
    ds_read_b64 v[66:67], v144 offset:72
    s_waitcnt lgkmcnt(15)
    v_mfma_f32_16x16x32_bf16 v[60:63], v[92:95], v[96:99], v[60:63]
    s_waitcnt lgkmcnt(15)
    v_mfma_f32_16x16x32_bf16 v[56:59], v[88:91], v[96:99], v[56:59]
    v_mfma_f32_16x16x32_bf16 v[60:63], v[88:91], v[100:103], v[60:63]
    ds_read_b64 v[92:93], v144 offset:3712
    ds_read_b64 v[94:95], v144 offset:3720
    s_waitcnt lgkmcnt(15)
    s_nop 0
    v_mfma_f32_16x16x32_bf16 v[52:55], v[84:87], v[96:99], v[52:55]
    v_mfma_f32_16x16x32_bf16 v[56:59], v[84:87], v[100:103], v[56:59]
    v_mfma_f32_16x16x32_bf16 v[60:63], v[84:87], v[104:107], v[60:63]
    ds_read_b64 v[88:89], v144 offset:3200
    ds_read_b64 v[90:91], v144 offset:3208
    s_waitcnt lgkmcnt(15)
    s_nop 0
    v_mfma_f32_16x16x32_bf16 v[48:51], v[80:83], v[96:99], v[48:51]
    v_mfma_f32_16x16x32_bf16 v[52:55], v[80:83], v[100:103], v[52:55]
    v_mfma_f32_16x16x32_bf16 v[56:59], v[80:83], v[104:107], v[56:59]
    v_mfma_f32_16x16x32_bf16 v[60:63], v[80:83], v[108:111], v[60:63]
    ds_read_b64 v[84:85], v144 offset:2688
    ds_read_b64 v[86:87], v144 offset:2696
    s_waitcnt lgkmcnt(15)
    s_nop 0
    v_mfma_f32_16x16x32_bf16 v[44:47], v[76:79], v[96:99], v[44:47]
    v_mfma_f32_16x16x32_bf16 v[48:51], v[76:79], v[100:103], v[48:51]
    v_mfma_f32_16x16x32_bf16 v[52:55], v[76:79], v[104:107], v[52:55]
    v_mfma_f32_16x16x32_bf16 v[56:59], v[76:79], v[108:111], v[56:59]
    v_mfma_f32_16x16x32_bf16 v[60:63], v[76:79], v[112:115], v[60:63]
    ds_read_b64 v[80:81], v144 offset:2176
    ds_read_b64 v[82:83], v144 offset:2184
    s_waitcnt lgkmcnt(14)
    s_nop 0
    v_mfma_f32_16x16x32_bf16 v[40:43], v[72:75], v[96:99], v[40:43]
    v_mfma_f32_16x16x32_bf16 v[44:47], v[72:75], v[100:103], v[44:47]
    v_mfma_f32_16x16x32_bf16 v[48:51], v[72:75], v[104:107], v[48:51]
    v_mfma_f32_16x16x32_bf16 v[52:55], v[72:75], v[108:111], v[52:55]
    v_mfma_f32_16x16x32_bf16 v[56:59], v[72:75], v[112:115], v[56:59]
    v_mfma_f32_16x16x32_bf16 v[60:63], v[72:75], v[116:119], v[60:63]
    ds_read_b64 v[76:77], v144 offset:1664
    ds_read_b64 v[78:79], v144 offset:1672
    s_waitcnt lgkmcnt(13)
    s_nop 0
    v_mfma_f32_16x16x32_bf16 v[36:39], v[68:71], v[96:99], v[36:39]
    v_mfma_f32_16x16x32_bf16 v[40:43], v[68:71], v[100:103], v[40:43]
    v_mfma_f32_16x16x32_bf16 v[44:47], v[68:71], v[104:107], v[44:47]
    v_mfma_f32_16x16x32_bf16 v[48:51], v[68:71], v[108:111], v[48:51]
    v_mfma_f32_16x16x32_bf16 v[52:55], v[68:71], v[112:115], v[52:55]
    v_mfma_f32_16x16x32_bf16 v[56:59], v[68:71], v[116:119], v[56:59]
    v_mfma_f32_16x16x32_bf16 v[60:63], v[68:71], v[120:123], v[60:63]
    ds_read_b64 v[72:73], v144 offset:1152
    ds_read_b64 v[74:75], v144 offset:1160
    s_waitcnt lgkmcnt(12)
    s_nop 0
    v_mfma_f32_16x16x32_bf16 v[32:35], v[64:67], v[96:99], v[32:35]
    v_mfma_f32_16x16x32_bf16 v[36:39], v[64:67], v[100:103], v[36:39]
    v_mfma_f32_16x16x32_bf16 v[40:43], v[64:67], v[104:107], v[40:43]
    v_mfma_f32_16x16x32_bf16 v[44:47], v[64:67], v[108:111], v[44:47]
    v_mfma_f32_16x16x32_bf16 v[48:51], v[64:67], v[112:115], v[48:51]
    v_mfma_f32_16x16x32_bf16 v[52:55], v[64:67], v[116:119], v[52:55]
    v_mfma_f32_16x16x32_bf16 v[56:59], v[64:67], v[120:123], v[56:59]
    v_mfma_f32_16x16x32_bf16 v[60:63], v[64:67], v[124:127], v[60:63]
    ds_read_b64 v[68:69], v144 offset:640
    ds_read_b64 v[70:71], v144 offset:648
    ds_read_b64 v[64:65], v144 offset:128
    ds_read_b64 v[66:67], v144 offset:136
    ds_read_b128 v[96:99], v145 offset:3712
    ds_read_b128 v[100:103], v145 offset:3200
    ds_read_b128 v[104:107], v145 offset:2688
    ds_read_b128 v[108:111], v145 offset:2176
    ds_read_b128 v[112:115], v145 offset:1664
    ds_read_b128 v[116:119], v145 offset:1152
    ds_read_b128 v[120:123], v145 offset:640
    ds_read_b128 v[124:127], v145 offset:128
    s_waitcnt lgkmcnt(7)
    s_nop 0
    v_mfma_f32_16x16x32_bf16 v[32:35], v[64:67], v[96:99], v[32:35]
    v_mfma_f32_16x16x32_bf16 v[36:39], v[68:71], v[96:99], v[36:39]
    v_mfma_f32_16x16x32_bf16 v[40:43], v[72:75], v[96:99], v[40:43]
    v_mfma_f32_16x16x32_bf16 v[44:47], v[76:79], v[96:99], v[44:47]
    v_mfma_f32_16x16x32_bf16 v[48:51], v[80:83], v[96:99], v[48:51]
    v_mfma_f32_16x16x32_bf16 v[52:55], v[84:87], v[96:99], v[52:55]
    v_mfma_f32_16x16x32_bf16 v[56:59], v[88:91], v[96:99], v[56:59]
    v_mfma_f32_16x16x32_bf16 v[60:63], v[92:95], v[96:99], v[60:63]
    s_waitcnt lgkmcnt(6)
    s_nop 0
    v_mfma_f32_16x16x32_bf16 v[36:39], v[64:67], v[100:103], v[36:39]
    v_mfma_f32_16x16x32_bf16 v[40:43], v[68:71], v[100:103], v[40:43]
    v_mfma_f32_16x16x32_bf16 v[44:47], v[72:75], v[100:103], v[44:47]
    v_mfma_f32_16x16x32_bf16 v[48:51], v[76:79], v[100:103], v[48:51]
    v_mfma_f32_16x16x32_bf16 v[52:55], v[80:83], v[100:103], v[52:55]
    v_mfma_f32_16x16x32_bf16 v[56:59], v[84:87], v[100:103], v[56:59]
    v_mfma_f32_16x16x32_bf16 v[60:63], v[88:91], v[100:103], v[60:63]
    ds_read_b128 v[96:99], v145 offset:3776
    ds_read_b64 v[92:93], v144 offset:3776
    ds_read_b64 v[94:95], v144 offset:3784
    s_waitcnt lgkmcnt(8)
    s_nop 0
    v_mfma_f32_16x16x32_bf16 v[40:43], v[64:67], v[104:107], v[40:43]
    v_mfma_f32_16x16x32_bf16 v[44:47], v[68:71], v[104:107], v[44:47]
    v_mfma_f32_16x16x32_bf16 v[48:51], v[72:75], v[104:107], v[48:51]
    v_mfma_f32_16x16x32_bf16 v[52:55], v[76:79], v[104:107], v[52:55]
    v_mfma_f32_16x16x32_bf16 v[56:59], v[80:83], v[104:107], v[56:59]
    v_mfma_f32_16x16x32_bf16 v[60:63], v[84:87], v[104:107], v[60:63]
    ds_read_b128 v[100:103], v145 offset:3264
    ds_read_b64 v[88:89], v144 offset:3264
    ds_read_b64 v[90:91], v144 offset:3272
    s_waitcnt lgkmcnt(10)
    s_nop 0
    v_mfma_f32_16x16x32_bf16 v[44:47], v[64:67], v[108:111], v[44:47]
    v_mfma_f32_16x16x32_bf16 v[48:51], v[68:71], v[108:111], v[48:51]
    v_mfma_f32_16x16x32_bf16 v[52:55], v[72:75], v[108:111], v[52:55]
    v_mfma_f32_16x16x32_bf16 v[56:59], v[76:79], v[108:111], v[56:59]
    v_mfma_f32_16x16x32_bf16 v[60:63], v[80:83], v[108:111], v[60:63]
    ds_read_b128 v[104:107], v145 offset:2752
    ds_read_b64 v[84:85], v144 offset:2752
    ds_read_b64 v[86:87], v144 offset:2760
    s_waitcnt lgkmcnt(12)
    s_nop 0
    v_mfma_f32_16x16x32_bf16 v[48:51], v[64:67], v[112:115], v[48:51]
    v_mfma_f32_16x16x32_bf16 v[52:55], v[68:71], v[112:115], v[52:55]
    v_mfma_f32_16x16x32_bf16 v[56:59], v[72:75], v[112:115], v[56:59]
    v_mfma_f32_16x16x32_bf16 v[60:63], v[76:79], v[112:115], v[60:63]
    ds_read_b128 v[108:111], v145 offset:2240
    ds_read_b64 v[80:81], v144 offset:2240
    ds_read_b64 v[82:83], v144 offset:2248
    s_waitcnt lgkmcnt(14)
    s_nop 0
    v_mfma_f32_16x16x32_bf16 v[52:55], v[64:67], v[116:119], v[52:55]
    v_mfma_f32_16x16x32_bf16 v[56:59], v[68:71], v[116:119], v[56:59]
    v_mfma_f32_16x16x32_bf16 v[60:63], v[72:75], v[116:119], v[60:63]
    ds_read_b128 v[112:115], v145 offset:1728
    ds_read_b64 v[76:77], v144 offset:1728
    ds_read_b64 v[78:79], v144 offset:1736
    s_waitcnt lgkmcnt(15)
    s_nop 0
    v_mfma_f32_16x16x32_bf16 v[56:59], v[64:67], v[120:123], v[56:59]
    v_mfma_f32_16x16x32_bf16 v[60:63], v[68:71], v[120:123], v[60:63]
    ds_read_b128 v[116:119], v145 offset:1216
    ds_read_b64 v[72:73], v144 offset:1216
    ds_read_b64 v[74:75], v144 offset:1224
    s_waitcnt lgkmcnt(15)
    s_nop 0
    v_mfma_f32_16x16x32_bf16 v[60:63], v[64:67], v[124:127], v[60:63]
    ds_read_b128 v[120:123], v145 offset:704
    ds_read_b64 v[68:69], v144 offset:704
    ds_read_b64 v[70:71], v144 offset:712
    ds_read_b128 v[124:127], v145 offset:192
    ds_read_b64 v[64:65], v144 offset:192
    ds_read_b64 v[66:67], v144 offset:200
    s_waitcnt lgkmcnt(15)
    v_mfma_f32_16x16x32_bf16 v[60:63], v[92:95], v[96:99], v[60:63]
    s_waitcnt lgkmcnt(15)
    v_mfma_f32_16x16x32_bf16 v[56:59], v[88:91], v[96:99], v[56:59]
    v_mfma_f32_16x16x32_bf16 v[60:63], v[88:91], v[100:103], v[60:63]
    s_waitcnt lgkmcnt(15)
    v_mfma_f32_16x16x32_bf16 v[52:55], v[84:87], v[96:99], v[52:55]
    v_mfma_f32_16x16x32_bf16 v[56:59], v[84:87], v[100:103], v[56:59]
    v_mfma_f32_16x16x32_bf16 v[60:63], v[84:87], v[104:107], v[60:63]
    s_waitcnt lgkmcnt(12)
    v_mfma_f32_16x16x32_bf16 v[48:51], v[80:83], v[96:99], v[48:51]
    v_mfma_f32_16x16x32_bf16 v[52:55], v[80:83], v[100:103], v[52:55]
    v_mfma_f32_16x16x32_bf16 v[56:59], v[80:83], v[104:107], v[56:59]
    v_mfma_f32_16x16x32_bf16 v[60:63], v[80:83], v[108:111], v[60:63]
    s_waitcnt lgkmcnt(9)
    s_nop 0
    v_mfma_f32_16x16x32_bf16 v[44:47], v[76:79], v[96:99], v[44:47]
    v_mfma_f32_16x16x32_bf16 v[48:51], v[76:79], v[100:103], v[48:51]
    v_mfma_f32_16x16x32_bf16 v[52:55], v[76:79], v[104:107], v[52:55]
    v_mfma_f32_16x16x32_bf16 v[56:59], v[76:79], v[108:111], v[56:59]
    v_mfma_f32_16x16x32_bf16 v[60:63], v[76:79], v[112:115], v[60:63]
    s_waitcnt lgkmcnt(6)
    s_nop 0
    v_mfma_f32_16x16x32_bf16 v[40:43], v[72:75], v[96:99], v[40:43]
    v_mfma_f32_16x16x32_bf16 v[44:47], v[72:75], v[100:103], v[44:47]
    v_mfma_f32_16x16x32_bf16 v[48:51], v[72:75], v[104:107], v[48:51]
    v_mfma_f32_16x16x32_bf16 v[52:55], v[72:75], v[108:111], v[52:55]
    v_mfma_f32_16x16x32_bf16 v[56:59], v[72:75], v[112:115], v[56:59]
    v_mfma_f32_16x16x32_bf16 v[60:63], v[72:75], v[116:119], v[60:63]
    s_waitcnt lgkmcnt(3)
    s_nop 0
    v_mfma_f32_16x16x32_bf16 v[36:39], v[68:71], v[96:99], v[36:39]
    v_mfma_f32_16x16x32_bf16 v[40:43], v[68:71], v[100:103], v[40:43]
    v_mfma_f32_16x16x32_bf16 v[44:47], v[68:71], v[104:107], v[44:47]
    v_mfma_f32_16x16x32_bf16 v[48:51], v[68:71], v[108:111], v[48:51]
    v_mfma_f32_16x16x32_bf16 v[52:55], v[68:71], v[112:115], v[52:55]
    v_mfma_f32_16x16x32_bf16 v[56:59], v[68:71], v[116:119], v[56:59]
    v_mfma_f32_16x16x32_bf16 v[60:63], v[68:71], v[120:123], v[60:63]
    s_waitcnt lgkmcnt(0)
    s_nop 0
    v_mfma_f32_16x16x32_bf16 v[32:35], v[64:67], v[96:99], v[32:35]
    v_mfma_f32_16x16x32_bf16 v[36:39], v[64:67], v[100:103], v[36:39]
    v_mfma_f32_16x16x32_bf16 v[40:43], v[64:67], v[104:107], v[40:43]
    v_mfma_f32_16x16x32_bf16 v[44:47], v[64:67], v[108:111], v[44:47]
    v_mfma_f32_16x16x32_bf16 v[48:51], v[64:67], v[112:115], v[48:51]
    v_mfma_f32_16x16x32_bf16 v[52:55], v[64:67], v[116:119], v[52:55]
    v_mfma_f32_16x16x32_bf16 v[56:59], v[64:67], v[120:123], v[56:59]
    v_mfma_f32_16x16x32_bf16 v[60:63], v[64:67], v[124:127], v[60:63]
    s_nop 0
    s_nop 0
    ds_write_b128 v146, v[32:35] offset:0
    ds_write_b128 v146, v[36:39] offset:1024
    ds_write_b128 v146, v[40:43] offset:2048
    ds_write_b128 v146, v[44:47] offset:3072
    ds_write_b128 v146, v[48:51] offset:4096
    ds_write_b128 v146, v[52:55] offset:5120
    ds_write_b128 v146, v[56:59] offset:6144
    ds_write_b128 v146, v[60:63] offset:7168
    s_lshl_b32 s83, s2, 14
    s_lshl_b32 s3, s58, 12
    s_add_u32 s83, s83, s3
    s_add_u32 s83, s83, 16777216
    v_lshlrev_b32 v9, 5, v1
    v_mov_b32 v129, s52
    v_mov_b32 v131, s53
    v_mov_b32 v133, s52
    v_mov_b32 v135, s53
    v_mov_b32 v137, s52
    v_mov_b32 v139, s53
    v_mov_b32 v141, s52
    v_mov_b32 v143, s53
    s_lshl_b32 s76, s54, 16
    s_and_b32 s77, s54, s51
    ds_read_b32 v28, v31 offset:120
    s_waitcnt lgkmcnt(0)
    v_mov_b32 v29, 1
    s_mov_b64 exec, 1
    ds_write_b32 v30, v29 offset:80
    s_mov_b64 exec, -1
    s_mov_b32 s85, 0
    v_cmp_eq_u32 vcc, 0, v28
    s_cbranch_vccnz L_ne_31
    s_mov_b32 s85, 1
    buffer_load_dwordx4 v[96:99], v13, s[4:7], s65 offen sc1
    s_add_u32 s65, s65, 1024
    s_cmp_eq_u32 s65, s67
    s_cselect_b32 s65, s64, s65
    buffer_load_dwordx4 v[100:103], v13, s[4:7], s65 offen sc1
    s_add_u32 s65, s65, 1024
    s_cmp_eq_u32 s65, s67
    s_cselect_b32 s65, s64, s65
    buffer_load_dwordx4 v[104:107], v13, s[4:7], s65 offen sc1
    s_add_u32 s65, s65, 1024
    s_cmp_eq_u32 s65, s67
    s_cselect_b32 s65, s64, s65
    buffer_load_dwordx4 v[108:111], v13, s[4:7], s65 offen sc1
    s_add_u32 s65, s65, 1024
    s_cmp_eq_u32 s65, s67
    s_cselect_b32 s65, s64, s65
    buffer_load_dwordx4 v[112:115], v13, s[4:7], s65 offen sc1
    s_add_u32 s65, s65, 1024
    s_cmp_eq_u32 s65, s67
    s_cselect_b32 s65, s64, s65
    buffer_load_dwordx4 v[116:119], v13, s[4:7], s65 offen sc1
    s_add_u32 s65, s65, 1024
    s_cmp_eq_u32 s65, s67
    s_cselect_b32 s65, s64, s65
L_ne_31:
    s_mov_b32 s3, 0
L_fs_32:
    ds_read_b128 v[24:27], v31 offset:80
    s_waitcnt lgkmcnt(0)
    v_min3_u32 v24, v24, v25, v26
    v_min_u32 v24, v24, v27
    v_cmp_gt_u32 vcc, 1, v24
    s_cbranch_vccz L_fo_33
    s_add_u32 s3, s3, 1
    s_cmp_gt_u32 s3, 400000
    s_cbranch_scc1 L_fo_33
    s_sleep 1
    s_branch L_fs_32
L_fo_33:
    s_nop 0
    ds_read_b128 v[32:35], v147 offset:0
    ds_read_b128 v[36:39], v147 offset:8192
    ds_read_b128 v[40:43], v147 offset:16384
    ds_read_b128 v[44:47], v147 offset:24576
    ds_read_b64 v[64:65], v148 offset:512
    ds_read_b64 v[66:67], v148 offset:5120
    ds_read_b128 v[48:51], v147 offset:1024
    ds_read_b128 v[52:55], v147 offset:9216
    ds_read_b128 v[56:59], v147 offset:17408
    ds_read_b128 v[60:63], v147 offset:25600
    ds_read_b64 v[68:69], v148 offset:0
    ds_read_b64 v[70:71], v148 offset:4608
    s_waitcnt lgkmcnt(0)
    v_mov_b32 v29, 1
    s_mov_b64 exec, 1
    ds_write_b32 v30, v29 offset:96
    s_mov_b64 exec, -1
    v_add_f32 v32, v32, v36
    v_add_f32 v33, v33, v37
    v_add_f32 v34, v34, v38
    v_add_f32 v35, v35, v39
    v_add_f32 v40, v40, v44
    v_add_f32 v41, v41, v45
    v_add_f32 v42, v42, v46
    v_add_f32 v43, v43, v47
    v_and_b32 v72, s51, v65
    v_and_b32 v73, s51, v67
    v_lshlrev_b32 v74, 16, v65
    v_lshlrev_b32 v75, 16, v67
    v_and_b32 v76, s51, v64
    v_and_b32 v77, s51, v66
    v_lshlrev_b32 v78, 16, v64
    v_lshlrev_b32 v79, 16, v66
    v_mul_f32 v72, s76, v72
    v_mul_f32 v73, s77, v73
    v_mul_f32 v74, s76, v74
    v_mul_f32 v75, s77, v75
    v_mul_f32 v76, s76, v76
    v_mul_f32 v77, s77, v77
    v_mul_f32 v78, s76, v78
    v_mul_f32 v79, s77, v79
    v_cvt_pk_bf16_f32 v80, v72, v73
    v_cvt_pk_bf16_f32 v84, v32, v40
    v_cvt_pk_bf16_f32 v81, v74, v75
    v_cvt_pk_bf16_f32 v85, v33, v41
    v_cvt_pk_bf16_f32 v82, v76, v77
    v_cvt_pk_bf16_f32 v86, v34, v42
    v_cvt_pk_bf16_f32 v83, v78, v79
    v_cvt_pk_bf16_f32 v87, v35, v43
    v_lshlrev_b32 v72, 16, v80
    v_and_b32 v73, s51, v80
    v_lshlrev_b32 v88, 16, v84
    v_and_b32 v89, s51, v84
    v_lshlrev_b32 v74, 16, v81
    v_and_b32 v75, s51, v81
    v_lshlrev_b32 v90, 16, v85
    v_and_b32 v91, s51, v85
    v_lshlrev_b32 v76, 16, v82
    v_and_b32 v77, s51, v82
    v_lshlrev_b32 v92, 16, v86
    v_and_b32 v93, s51, v86
    v_lshlrev_b32 v78, 16, v83
    v_and_b32 v79, s51, v83
    v_lshlrev_b32 v94, 16, v87
    v_and_b32 v95, s51, v87
    v_add_f32 v72, v72, v88
    v_add_f32 v73, v73, v89
    v_add_f32 v74, v74, v90
    v_add_f32 v75, v75, v91
    v_add_f32 v76, v76, v92
    v_add_f32 v77, v77, v93
    v_add_f32 v78, v78, v94
    v_add_f32 v79, v79, v95
    v_cvt_pk_bf16_f32 v128, v72, v73
    v_cvt_pk_bf16_f32 v130, v74, v75
    v_cvt_pk_bf16_f32 v132, v76, v77
    v_cvt_pk_bf16_f32 v134, v78, v79
    buffer_store_dwordx4 v[128:131], v13, s[4:7], s83 offen offset:0 sc1
    buffer_store_dwordx4 v[132:135], v13, s[4:7], s83 offen offset:1024 sc1
    v_add_f32 v48, v48, v52
    v_add_f32 v49, v49, v53
    v_add_f32 v50, v50, v54
    v_add_f32 v51, v51, v55
    v_add_f32 v56, v56, v60
    v_add_f32 v57, v57, v61
    v_add_f32 v58, v58, v62
    v_add_f32 v59, v59, v63
    v_and_b32 v72, s51, v69
    v_and_b32 v73, s51, v71
    v_lshlrev_b32 v74, 16, v69
    v_lshlrev_b32 v75, 16, v71
    v_and_b32 v76, s51, v68
    v_and_b32 v77, s51, v70
    v_lshlrev_b32 v78, 16, v68
    v_lshlrev_b32 v79, 16, v70
    v_mul_f32 v72, s76, v72
    v_mul_f32 v73, s77, v73
    v_mul_f32 v74, s76, v74
    v_mul_f32 v75, s77, v75
    v_mul_f32 v76, s76, v76
    v_mul_f32 v77, s77, v77
    v_mul_f32 v78, s76, v78
    v_mul_f32 v79, s77, v79
    v_cvt_pk_bf16_f32 v80, v72, v73
    v_cvt_pk_bf16_f32 v84, v48, v56
    v_cvt_pk_bf16_f32 v81, v74, v75
    v_cvt_pk_bf16_f32 v85, v49, v57
    v_cvt_pk_bf16_f32 v82, v76, v77
    v_cvt_pk_bf16_f32 v86, v50, v58
    v_cvt_pk_bf16_f32 v83, v78, v79
    v_cvt_pk_bf16_f32 v87, v51, v59
    v_lshlrev_b32 v72, 16, v80
    v_and_b32 v73, s51, v80
    v_lshlrev_b32 v88, 16, v84
    v_and_b32 v89, s51, v84
    v_lshlrev_b32 v74, 16, v81
    v_and_b32 v75, s51, v81
    v_lshlrev_b32 v90, 16, v85
    v_and_b32 v91, s51, v85
    v_lshlrev_b32 v76, 16, v82
    v_and_b32 v77, s51, v82
    v_lshlrev_b32 v92, 16, v86
    v_and_b32 v93, s51, v86
    v_lshlrev_b32 v78, 16, v83
    v_and_b32 v79, s51, v83
    v_lshlrev_b32 v94, 16, v87
    v_and_b32 v95, s51, v87
    v_add_f32 v72, v72, v88
    v_add_f32 v73, v73, v89
    v_add_f32 v74, v74, v90
    v_add_f32 v75, v75, v91
    v_add_f32 v76, v76, v92
    v_add_f32 v77, v77, v93
    v_add_f32 v78, v78, v94
    v_add_f32 v79, v79, v95
    v_cvt_pk_bf16_f32 v136, v72, v73
    v_cvt_pk_bf16_f32 v138, v74, v75
    v_cvt_pk_bf16_f32 v140, v76, v77
    v_cvt_pk_bf16_f32 v142, v78, v79
    buffer_store_dwordx4 v[136:139], v13, s[4:7], s83 offen offset:2048 sc1
    buffer_store_dwordx4 v[140:143], v13, s[4:7], s83 offen offset:3072 sc1
    s_setprio 0
    s_cmp_eq_u32 s85, 1
    s_cbranch_scc1 L_nl_34
    s_mov_b32 s3, 0
L_ws_35:
    ds_read_b32 v28, v31 offset:120
    s_waitcnt lgkmcnt(0)
    v_cmp_eq_u32 vcc, 0, v28
    s_cbranch_vccz L_wo_36
    s_add_u32 s3, s3, 1
    s_cmp_gt_u32 s3, 400000
    s_cbranch_scc1 L_wo_36
    s_sleep 2
    s_branch L_ws_35
L_wo_36:
    buffer_load_dwordx4 v[96:99], v13, s[4:7], s65 offen sc1
    s_add_u32 s65, s65, 1024
    s_cmp_eq_u32 s65, s67
    s_cselect_b32 s65, s64, s65
    buffer_load_dwordx4 v[100:103], v13, s[4:7], s65 offen sc1
    s_add_u32 s65, s65, 1024
    s_cmp_eq_u32 s65, s67
    s_cselect_b32 s65, s64, s65
    buffer_load_dwordx4 v[104:107], v13, s[4:7], s65 offen sc1
    s_add_u32 s65, s65, 1024
    s_cmp_eq_u32 s65, s67
    s_cselect_b32 s65, s64, s65
    buffer_load_dwordx4 v[108:111], v13, s[4:7], s65 offen sc1
    s_add_u32 s65, s65, 1024
    s_cmp_eq_u32 s65, s67
    s_cselect_b32 s65, s64, s65
    buffer_load_dwordx4 v[112:115], v13, s[4:7], s65 offen sc1
    s_add_u32 s65, s65, 1024
    s_cmp_eq_u32 s65, s67
    s_cselect_b32 s65, s64, s65
    buffer_load_dwordx4 v[116:119], v13, s[4:7], s65 offen sc1
    s_add_u32 s65, s65, 1024
    s_cmp_eq_u32 s65, s67
    s_cselect_b32 s65, s64, s65
    s_mov_b64 exec, 1
    buffer_load_dword v28, v22, s[44:47], 0 offen
    buffer_load_dword v28, v22, s[44:47], 0 offen
    buffer_load_dword v28, v22, s[44:47], 0 offen
    buffer_load_dword v28, v22, s[44:47], 0 offen
    s_mov_b64 exec, -1
L_nl_34:
    s_waitcnt vmcnt(9)
    v_mfma_f32_32x32x16_bf16 v[32:47], v[160:163], v[96:99], 0
    v_mfma_f32_32x32x16_bf16 v[48:63], v[164:167], v[96:99], 0
    buffer_load_dwordx4 v[120:123], v13, s[4:7], s65 offen sc1
    s_add_u32 s65, s65, 1024
    s_cmp_eq_u32 s65, s67
    s_cselect_b32 s65, s64, s65
    s_waitcnt vmcnt(9)
    v_mfma_f32_32x32x16_bf16 v[32:47], v[168:171], v[100:103], v[32:47]
    v_mfma_f32_32x32x16_bf16 v[48:63], v[172:175], v[100:103], v[48:63]
    buffer_load_dwordx4 v[124:127], v13, s[4:7], s65 offen sc1
    s_add_u32 s65, s65, 1024
    s_cmp_eq_u32 s65, s67
    s_cselect_b32 s65, s64, s65
    s_waitcnt vmcnt(9)
    v_mfma_f32_32x32x16_bf16 v[32:47], v[176:179], v[104:107], v[32:47]
    v_mfma_f32_32x32x16_bf16 v[48:63], v[180:183], v[104:107], v[48:63]
    buffer_load_dwordx4 v[96:99], v13, s[4:7], s65 offen sc1
    s_add_u32 s65, s65, 1024
    s_cmp_eq_u32 s65, s67
    s_cselect_b32 s65, s64, s65
    s_waitcnt vmcnt(9)
    v_mfma_f32_32x32x16_bf16 v[32:47], v[184:187], v[108:111], v[32:47]
    v_mfma_f32_32x32x16_bf16 v[48:63], v[188:191], v[108:111], v[48:63]
    buffer_load_dwordx4 v[100:103], v13, s[4:7], s65 offen sc1
    s_add_u32 s65, s65, 1024
    s_cmp_eq_u32 s65, s67
    s_cselect_b32 s65, s64, s65
    s_waitcnt vmcnt(9)
    v_mfma_f32_32x32x16_bf16 v[32:47], v[192:195], v[112:115], v[32:47]
    v_mfma_f32_32x32x16_bf16 v[48:63], v[196:199], v[112:115], v[48:63]
    buffer_load_dwordx4 v[104:107], v13, s[4:7], s65 offen sc1
    s_add_u32 s65, s65, 1024
    s_cmp_eq_u32 s65, s67
    s_cselect_b32 s65, s64, s65
    s_waitcnt vmcnt(9)
    v_mfma_f32_32x32x16_bf16 v[32:47], v[200:203], v[116:119], v[32:47]
    v_mfma_f32_32x32x16_bf16 v[48:63], v[204:207], v[116:119], v[48:63]
    buffer_load_dwordx4 v[108:111], v13, s[4:7], s65 offen sc1
    s_add_u32 s65, s65, 1024
    s_cmp_eq_u32 s65, s67
    s_cselect_b32 s65, s64, s65
    s_add_u32 s65, s65, s68
    s_add_u32 s67, s67, s68
    s_add_u32 s64, s64, s68
    s_waitcnt vmcnt(5)
    v_mfma_f32_32x32x16_bf16 v[32:47], v[208:211], v[120:123], v[32:47]
    v_mfma_f32_32x32x16_bf16 v[48:63], v[212:215], v[120:123], v[48:63]
    buffer_load_dwordx4 v[112:115], v13, s[4:7], s65 offen sc1
    s_add_u32 s65, s65, 1024
    s_cmp_eq_u32 s65, s67
    s_cselect_b32 s65, s64, s65
    s_waitcnt vmcnt(5)
    v_mfma_f32_32x32x16_bf16 v[32:47], v[216:219], v[124:127], v[32:47]
    v_mfma_f32_32x32x16_bf16 v[48:63], v[220:223], v[124:127], v[48:63]
    buffer_load_dwordx4 v[116:119], v13, s[4:7], s65 offen sc1
    s_add_u32 s65, s65, 1024
    s_cmp_eq_u32 s65, s67
    s_cselect_b32 s65, s64, s65
    s_waitcnt vmcnt(5)
    v_mfma_f32_32x32x16_bf16 v[32:47], v[224:227], v[96:99], v[32:47]
    v_mfma_f32_32x32x16_bf16 v[48:63], v[228:231], v[96:99], v[48:63]
    buffer_load_dwordx4 v[120:123], v13, s[4:7], s65 offen sc1
    s_add_u32 s65, s65, 1024
    s_cmp_eq_u32 s65, s67
    s_cselect_b32 s65, s64, s65
    s_waitcnt vmcnt(5)
    v_mfma_f32_32x32x16_bf16 v[32:47], v[232:235], v[100:103], v[32:47]
    v_mfma_f32_32x32x16_bf16 v[48:63], v[236:239], v[100:103], v[48:63]
    buffer_load_dwordx4 v[124:127], v13, s[4:7], s65 offen sc1
    s_add_u32 s65, s65, 1024
    s_cmp_eq_u32 s65, s67
    s_cselect_b32 s65, s64, s65
    s_waitcnt vmcnt(5)
    v_mfma_f32_32x32x16_bf16 v[32:47], v[240:243], v[104:107], v[32:47]
    v_mfma_f32_32x32x16_bf16 v[48:63], v[244:247], v[104:107], v[48:63]
    buffer_load_dwordx4 v[96:99], v13, s[4:7], s65 offen sc1
    s_add_u32 s65, s65, 1024
    s_cmp_eq_u32 s65, s67
    s_cselect_b32 s65, s64, s65
    s_waitcnt vmcnt(5)
    v_mfma_f32_32x32x16_bf16 v[32:47], v[248:251], v[108:111], v[32:47]
    v_mfma_f32_32x32x16_bf16 v[48:63], v[252:255], v[108:111], v[48:63]
    buffer_load_dwordx4 v[100:103], v13, s[4:7], s65 offen sc1
    s_add_u32 s65, s65, 1024
    s_cmp_eq_u32 s65, s67
    s_cselect_b32 s65, s64, s65
    s_mov_b32 s3, 0
L_fs_37:
    ds_read_b128 v[24:27], v31 offset:96
    s_waitcnt lgkmcnt(0)
    v_min3_u32 v24, v24, v25, v26
    v_min_u32 v24, v24, v27
    v_cmp_gt_u32 vcc, 1, v24
    s_cbranch_vccz L_fo_38
    s_add_u32 s3, s3, 1
    s_cmp_gt_u32 s3, 400000
    s_cbranch_scc1 L_fo_38
    s_sleep 1
    s_branch L_fs_37
L_fo_38:
    s_waitcnt vmcnt(5)
    v_mfma_f32_32x32x16_bf16 v[64:79], v[160:163], v[112:115], 0
    v_mfma_f32_32x32x16_bf16 v[80:95], v[164:167], v[112:115], 0
    buffer_load_dwordx4 v[104:107], v13, s[4:7], s65 offen sc1
    s_add_u32 s65, s65, 1024
    s_cmp_eq_u32 s65, s67
    s_cselect_b32 s65, s64, s65
    buffer_load_dwordx4 v[128:131], v21, s[8:11], s86 offen
    buffer_load_dwordx4 v[132:135], v22, s[44:47], s87 offen
    buffer_load_dwordx4 v[136:139], v23, s[4:7], s88 offen sc1
    s_waitcnt vmcnt(8)
    v_mfma_f32_32x32x16_bf16 v[64:79], v[168:171], v[116:119], v[64:79]
    v_mfma_f32_32x32x16_bf16 v[80:95], v[172:175], v[116:119], v[80:95]
    buffer_load_dwordx4 v[108:111], v13, s[4:7], s65 offen sc1
    s_add_u32 s65, s65, 1024
    s_cmp_eq_u32 s65, s67
    s_cselect_b32 s65, s64, s65
    ds_write_b128 v14, v[32:35] offset:0
    s_waitcnt vmcnt(8)
    v_mfma_f32_32x32x16_bf16 v[64:79], v[176:179], v[120:123], v[64:79]
    v_mfma_f32_32x32x16_bf16 v[80:95], v[180:183], v[120:123], v[80:95]
    buffer_load_dwordx4 v[112:115], v13, s[4:7], s65 offen sc1
    s_add_u32 s65, s65, 1024
    s_cmp_eq_u32 s65, s67
    s_cselect_b32 s65, s64, s65
    ds_write_b128 v15, v[36:39] offset:0
    s_waitcnt vmcnt(8)
    v_mfma_f32_32x32x16_bf16 v[64:79], v[184:187], v[124:127], v[64:79]
    v_mfma_f32_32x32x16_bf16 v[80:95], v[188:191], v[124:127], v[80:95]
    buffer_load_dwordx4 v[116:119], v13, s[4:7], s65 offen sc1
    s_add_u32 s65, s65, 1024
    s_cmp_eq_u32 s65, s67
    s_cselect_b32 s65, s64, s65
    ds_write_b128 v16, v[40:43] offset:0
    s_waitcnt vmcnt(8)
    v_mfma_f32_32x32x16_bf16 v[64:79], v[192:195], v[96:99], v[64:79]
    v_mfma_f32_32x32x16_bf16 v[80:95], v[196:199], v[96:99], v[80:95]
    buffer_load_dwordx4 v[120:123], v13, s[4:7], s65 offen sc1
    s_add_u32 s65, s65, 1024
    s_cmp_eq_u32 s65, s67
    s_cselect_b32 s65, s64, s65
    ds_write_b128 v17, v[44:47] offset:0
    s_waitcnt vmcnt(8)
    v_mfma_f32_32x32x16_bf16 v[64:79], v[200:203], v[100:103], v[64:79]
    v_mfma_f32_32x32x16_bf16 v[80:95], v[204:207], v[100:103], v[80:95]
    buffer_load_dwordx4 v[124:127], v13, s[4:7], s65 offen sc1
    s_add_u32 s65, s65, 1024
    s_cmp_eq_u32 s65, s67
    s_cselect_b32 s65, s64, s65
    ds_write_b128 v14, v[48:51] offset:4096
    s_waitcnt vmcnt(8)
    v_mfma_f32_32x32x16_bf16 v[64:79], v[208:211], v[104:107], v[64:79]
    v_mfma_f32_32x32x16_bf16 v[80:95], v[212:215], v[104:107], v[80:95]
    ds_write_b128 v15, v[52:55] offset:4096
    s_waitcnt vmcnt(4)
    v_mfma_f32_32x32x16_bf16 v[64:79], v[216:219], v[108:111], v[64:79]
    v_mfma_f32_32x32x16_bf16 v[80:95], v[220:223], v[108:111], v[80:95]
    ds_write_b128 v16, v[56:59] offset:4096
    s_waitcnt vmcnt(5)
    s_mov_b32 s3, 0
L_spin_39:
    v_xor_b32 v137, s52, v137
    v_xor_b32 v139, s53, v139
    v_or_b32 v137, v137, v139
    v_cmp_ne_u32 vcc, 0, v137
    s_cbranch_vccz L_ok_40
    s_add_u32 s3, s3, 1
    s_cmp_gt_u32 s3, 20000
    s_cbranch_scc1 L_ok_40
    s_sleep 2
    buffer_load_dwordx4 v[136:139], v23, s[4:7], s88 offen sc1
    s_waitcnt vmcnt(0)
    s_branch L_spin_39
L_ok_40:
    s_waitcnt vmcnt(3)
    v_mfma_f32_32x32x16_bf16 v[64:79], v[224:227], v[112:115], v[64:79]
    v_lshlrev_b32 v152, 16, v128
    v_and_b32 v153, s51, v128
    v_lshlrev_b32 v168, 16, v132
    v_and_b32 v169, s51, v132
    v_lshlrev_b32 v154, 16, v129
    v_and_b32 v155, s51, v129
    v_lshlrev_b32 v170, 16, v133
    v_mfma_f32_32x32x16_bf16 v[80:95], v[228:231], v[112:115], v[80:95]
    v_and_b32 v171, s51, v133
    v_lshlrev_b32 v156, 16, v130
    v_and_b32 v157, s51, v130
    v_lshlrev_b32 v172, 16, v134
    v_and_b32 v173, s51, v134
    v_lshlrev_b32 v158, 16, v131
    v_and_b32 v159, s51, v131
    ds_write_b128 v17, v[60:63] offset:4096
    s_waitcnt vmcnt(2)
    v_mfma_f32_32x32x16_bf16 v[64:79], v[232:235], v[116:119], v[64:79]
    v_lshlrev_b32 v174, 16, v135
    v_and_b32 v175, s51, v135
    v_sub_f32 v160, v152, v136
    v_sub_f32 v161, v153, v136
    v_sub_f32 v162, v154, v136
    v_sub_f32 v163, v155, v136
    v_sub_f32 v164, v156, v136
    v_mfma_f32_32x32x16_bf16 v[80:95], v[236:239], v[116:119], v[80:95]
    v_sub_f32 v165, v157, v136
    v_sub_f32 v166, v158, v136
    v_sub_f32 v167, v159, v136
    v_cvt_pk_bf16_f32 v148, v160, v161
    v_cvt_pk_bf16_f32 v149, v162, v163
    v_cvt_pk_bf16_f32 v150, v164, v165
    v_cvt_pk_bf16_f32 v151, v166, v167
    s_waitcnt vmcnt(1)
    v_mfma_f32_32x32x16_bf16 v[64:79], v[240:243], v[120:123], v[64:79]
    v_lshlrev_b32 v160, 16, v148
    v_and_b32 v161, s51, v148
    v_lshlrev_b32 v162, 16, v149
    v_and_b32 v163, s51, v149
    v_lshlrev_b32 v164, 16, v150
    v_and_b32 v165, s51, v150
    v_lshlrev_b32 v166, 16, v151
    v_mfma_f32_32x32x16_bf16 v[80:95], v[244:247], v[120:123], v[80:95]
    v_and_b32 v167, s51, v151
    v_mul_f32 v160, v160, v138
    v_mul_f32 v161, v161, v138
    v_mul_f32 v162, v162, v138
    v_mul_f32 v163, v163, v138
    v_mul_f32 v164, v164, v138
    v_mul_f32 v165, v165, v138
    s_waitcnt vmcnt(0)
    v_mfma_f32_32x32x16_bf16 v[64:79], v[248:251], v[124:127], v[64:79]
    v_mul_f32 v166, v166, v138
    v_mul_f32 v167, v167, v138
    v_cvt_pk_bf16_f32 v148, v160, v161
    v_cvt_pk_bf16_f32 v149, v162, v163
    v_cvt_pk_bf16_f32 v150, v164, v165
    v_cvt_pk_bf16_f32 v151, v166, v167
    v_lshlrev_b32 v160, 16, v148
    v_mfma_f32_32x32x16_bf16 v[80:95], v[252:255], v[124:127], v[80:95]
    v_and_b32 v161, s51, v148
    v_lshlrev_b32 v162, 16, v149
    v_and_b32 v163, s51, v149
    v_lshlrev_b32 v164, 16, v150
    v_and_b32 v165, s51, v150
    v_lshlrev_b32 v166, 16, v151
    v_and_b32 v167, s51, v151
    s_add_u32 s3, s89, 0
    buffer_load_dwordx4 v[176:179], v19, s[4:7], s3 offen sc1
    s_add_u32 s3, s89, 16384
    buffer_load_dwordx4 v[180:183], v19, s[4:7], s3 offen sc1
    s_add_u32 s3, s89, 32768
    buffer_load_dwordx4 v[184:187], v19, s[4:7], s3 offen sc1
    s_add_u32 s3, s89, 49152
    buffer_load_dwordx4 v[188:191], v19, s[4:7], s3 offen sc1
    v_xor_b32 v14, 0x18000, v14
    v_xor_b32 v15, 0x18000, v15
    v_xor_b32 v16, 0x18000, v16
    v_xor_b32 v17, 0x18000, v17
    ds_write_b128 v14, v[64:67] offset:0
    ds_write_b128 v15, v[68:71] offset:0
    ds_write_b128 v16, v[72:75] offset:0
    ds_write_b128 v17, v[76:79] offset:0
    ds_write_b128 v14, v[80:83] offset:4096
    ds_write_b128 v15, v[84:87] offset:4096
    ds_write_b128 v16, v[88:91] offset:4096
    ds_write_b128 v17, v[92:95] offset:4096
    s_branch L_join
L_cpath:
    s_and_b32 s3, s50, 3
    s_mul_i32 s3, s3, 8064
    buffer_load_dwordx4 v[232:235], v14, s[92:95], s3 offen
    buffer_load_dwordx4 v[232:235], v14, s[92:95], s3 offen offset:3968
    s_and_b32 s100, s48, 1
    s_lshr_b32 s101, s48, 1
    s_lshl_b32 s3, s100, 6
    v_add_u32 v28, s3, v3
    v_lshlrev_b32 v28, 7, v28
    v_lshrrev_b32 v29, 1, v3
    v_and_b32 v29, 7, v29
    v_add_u32 v30, 0, v4
    v_xor_b32 v30, v30, v29
    v_lshlrev_b32 v30, 4, v30
    v_add_u32 v16, v28, v30
    v_add_u32 v30, 2, v4
    v_xor_b32 v30, v30, v29
    v_lshlrev_b32 v30, 4, v30
    v_add_u32 v17, v28, v30
    v_add_u32 v30, 4, v4
    v_xor_b32 v30, v30, v29
    v_lshlrev_b32 v30, 4, v30
    v_add_u32 v18, v28, v30
    v_add_u32 v30, 6, v4
    v_xor_b32 v30, v30, v29
    v_lshlrev_b32 v30, 4, v30
    v_add_u32 v19, v28, v30
    v_lshrrev_b32 v28, 4, v1
    v_and_b32 v28, 1, v28
    v_lshrrev_b32 v29, 2, v1
    v_and_b32 v29, 3, v29
    v_and_b32 v30, 3, v1
    v_lshlrev_b32 v31, 3, v4
    v_add_u32 v31, v31, v29
    v_lshlrev_b32 v31, 8, v31
    v_and_b32 v15, 1, v30
    v_lshlrev_b32 v15, 3, v15
    v_add_u32 v31, v31, v15
    v_add_u32 v31, 16384, v31
    v_lshlrev_b32 v28, 1, v28
    v_lshrrev_b32 v30, 1, v30
    v_add_u32 v28, v28, v30
    s_lshl_b32 s3, s101, 1
    s_add_u32 s3, s3, 0
    v_xor_b32 v15, s3, v29
    v_lshlrev_b32 v15, 2, v15
    v_add_u32 v15, v15, v28
    v_lshlrev_b32 v15, 4, v15
    v_add_u32 v20, v31, v15
    s_lshl_b32 s3, s101, 1
    s_add_u32 s3, s3, 1
    v_xor_b32 v15, s3, v29
    v_lshlrev_b32 v15, 2, v15
    v_add_u32 v15, v15, v28
    v_lshlrev_b32 v15, 4, v15
    v_add_u32 v21, v31, v15
    v_mov_b32 v26, 0
    v_mov_b32 v27, 0
    v_mov_b32 v28, 0
    v_mov_b32 v29, 0
    v_mov_b32 v30, 0x3f803f80
    v_lshlrev_b32 v12, 5, v1
    v_lshlrev_b32 v11, 1, v1
    v_mov_b32 v22, 141056
    s_lshl_b32 s3, s48, 2
    v_add_u32 v23, s3, v22
    s_waitcnt lgkmcnt(0)
    s_barrier
    s_mov_b64 s[12:13], s[66:67]
    s_mov_b64 s[16:17], s[68:69]
    s_mov_b64 s[20:21], s[70:71]
    s_mov_b64 s[32:33], s[82:83]
    s_mov_b64 s[8:9], s[64:65]
    s_mov_b64 s[40:41], s[80:81]
    s_mov_b64 s[4:5], s[90:91]
    s_mov_b64 s[28:29], s[78:79]
    s_mov_b64 s[24:25], s[72:73]
    s_mov_b64 s[36:37], s[86:87]
    s_mov_b64 s[44:45], s[84:85]
    s_lshr_b32 s99, s2, 6
    s_lshl_b32 s99, s99, 3
    s_add_u32 s99, s99, s49
    s_and_b32 s98, s50, 7
    v_lshrrev_b32 v7, 3, v1
    v_and_b32 v8, 7, v1
    v_lshlrev_b32 v10, 10, v7
    v_lshlrev_b32 v24, 4, v8
    v_add_u32 v10, v10, v24
    s_lshl_b32 s3, s99, 16
    s_lshl_b32 s72, s98, 7
    s_add_u32 s3, s3, s72
    s_lshl_b32 s72, s48, 13
    s_add_u32 s3, s3, s72
    v_add_u32 v10, s3, v10
    v_add_u32 v25, 0xffffe000, v10
    s_lshl_b32 s72, s48, 10
    s_add_u32 m0, s72, 141312
    s_mov_b32 s73, 24576
    buffer_load_dwordx4 v25, s[12:15], 0 offen lds
    s_add_u32 m0, s72, 145408
    s_nop 0
    s_nop 0
    buffer_load_dwordx4 v10, s[12:15], s73 offen lds
    s_add_u32 m0, s72, 150528
    s_mov_b32 s73, 32768
    buffer_load_dwordx4 v10, s[16:19], 0 offen lds
    s_add_u32 m0, s72, 154624
    s_nop 0
    buffer_load_dwordx4 v10, s[16:19], s73 offen lds
    s_cmp_eq_u32 s48, 0
    s_cselect_b32 exec_lo, -1, 0
    s_cselect_b32 exec_hi, -1, 0
    s_mov_b32 m0, 149504
    s_mov_b32 s73, 57344
    buffer_load_dwordx4 v10, s[12:15], s73 offen lds
    s_mov_b64 exec, -1
    s_lshl_b32 s3, s98, 9
    s_lshl_b32 s72, s48, 7
    s_add_u32 s3, s3, s72
    buffer_load_dwordx4 v[60:63], v24, s[20:23], s3 offen
    s_lshl_b32 s73, s56, 8
    s_lshl_b32 s3, s101, 7
    s_add_u32 s73, s73, s3
    buffer_load_ushort v237, v11, s[40:43], s73 offen
    s_mov_b32 s88, 4325376
    s_load_dword s52, s[4:5], s88
    s_lshl_b32 s87, s2, 2
    s_load_dword s54, s[74:75], s87
    s_mul_i32 s79, s58, 16
    s_mul_i32 s63, s62, 112
    s_add_u32 s63, s63, s79
    s_lshl_b32 s63, s63, 11
    s_add_u32 s63, s63, 12582912
    s_lshl_b32 s66, s62, 1
    s_sub_u32 s3, s66, 16
    s_cmp_ge_u32 s66, 16
    s_cselect_b32 s66, s3, s66
    s_and_b32 s69, s62, 1
    s_mov_b32 s70, s100
    s_mov_b32 s71, s101
    s_mov_b32 s67, s99
    s_mov_b32 s68, s98
    s_lshl_b32 s77, s55, 7
    s_lshl_b32 s3, s70, 6
    s_add_u32 s77, s77, s3
    s_lshl_b32 s77, s77, 5
    s_add_u32 s77, s77, 4194304
    s_add_u32 s78, s77, 1024
    v_lshlrev_b32 v6, 5, v3
    s_lshl_b32 s76, s48, 9
    s_add_u32 s76, s76, 159744
    v_lshlrev_b32 v9, 2, v1
    v_add_u32 v9, s76, v9
    s_lshl_b32 s3, s48, 5
    s_add_u32 s3, s3, 141952
    v_lshlrev_b32 v64, 10, v7
    v_lshlrev_b32 v65, 2, v8
    v_add_u32 v64, v64, v65
    v_add_u32 v64, s3, v64
    v_add_u32 v65, 768, v64
    v_add_u32 v66, 8576, v64
    s_lshl_b32 s72, s48, 11
    s_add_u32 s72, s72, 131072
    v_sub_u32 v67, 7, v7
    v_xor_b32 v67, v67, v8
    v_lshlrev_b32 v67, 4, v67
    v_lshlrev_b32 v68, 8, v8
    v_add_u32 v67, v67, v68
    v_add_u32 v67, s72, v67
    v_lshrrev_b32 v71, 4, v1
    v_lshlrev_b32 v69, 7, v7
    v_add_u32 v69, s72, v69
    v_xor_b32 v68, v8, v71
    v_lshlrev_b32 v68, 4, v68
    v_add_u32 v68, v68, v69
    v_add_u32 v71, 4, v71
    v_xor_b32 v71, v8, v71
    v_lshlrev_b32 v71, 4, v71
    v_add_u32 v69, v71, v69
    v_lshlrev_b32 v70, 12, v7
    v_add_u32 v70, v70, v24
    v_mov_b32 v31, 141056
    s_waitcnt lgkmcnt(0)
    s_mul_i32 s52, s52, 1664525
    s_add_u32 s52, s52, 1013904223
    s_xor_b32 s53, s52, 0x5bd1e995
    s_waitcnt vmcnt(0)
    v_mov_b32 v15, 1
    s_mov_b64 exec, 1
    ds_write_b32 v23, v15 offset:32
    s_mov_b64 exec, -1
    v_lshlrev_b32 v118, 16, v60
    v_lshlrev_b32 v119, 16, v62
    v_and_b32 v120, s51, v60
    v_and_b32 v121, s51, v62
    v_lshlrev_b32 v122, 16, v61
    v_lshlrev_b32 v123, 16, v63
    v_and_b32 v124, s51, v61
    v_and_b32 v125, s51, v63
    s_mov_b32 s3, 0
L_fs_41:
    ds_read_b128 v[240:243], v31 offset:32
    s_waitcnt lgkmcnt(0)
    v_min3_u32 v240, v240, v241, v242
    v_min_u32 v240, v240, v243
    v_cmp_gt_u32 vcc, 1, v240
    s_cbranch_vccz L_fo_42
    s_add_u32 s3, s3, 1
    s_cmp_gt_u32 s3, 400000
    s_cbranch_scc1 L_fo_42
    s_sleep 1
    s_branch L_fs_41
L_fo_42:
    ds_read2_b32 v[40:41], v64 offset0:0 offset1:32
    ds_read2_b32 v[42:43], v64 offset0:64 offset1:96
    ds_read2_b32 v[44:45], v64 offset0:128 offset1:160
    ds_read2_b32 v[46:47], v65 offset0:0 offset1:32
    ds_read2_b32 v[48:49], v65 offset0:64 offset1:96
    ds_read2_b32 v[50:51], v65 offset0:128 offset1:160
    ds_read2_b32 v[52:53], v66 offset0:0 offset1:32
    ds_read2_b32 v[54:55], v66 offset0:64 offset1:96
    ds_read2_b32 v[56:57], v66 offset0:128 offset1:160
    ds_read2_b32 v[58:59], v66 offset0:192 offset1:224
    s_waitcnt lgkmcnt(4)
    v_lshlrev_b32 v96, 16, v40
    v_and_b32 v97, s51, v40
    v_lshlrev_b32 v98, 16, v41
    v_and_b32 v99, s51, v41
    v_lshlrev_b32 v100, 16, v42
    v_and_b32 v101, s51, v42
    v_lshlrev_b32 v102, 16, v43
    v_and_b32 v103, s51, v43
    v_lshlrev_b32 v104, 16, v44
    v_and_b32 v105, s51, v44
    v_lshlrev_b32 v106, 16, v45
    v_and_b32 v107, s51, v45
    v_lshlrev_b32 v108, 16, v46
    v_and_b32 v109, s51, v46
    v_lshlrev_b32 v110, 16, v47
    v_and_b32 v111, s51, v47
    v_lshlrev_b32 v112, 16, v48
    v_and_b32 v113, s51, v48
    v_lshlrev_b32 v114, 16, v49
    v_and_b32 v115, s51, v49
    v_lshlrev_b32 v116, 16, v50
    v_and_b32_e64 v117, s51, v50
    v_pk_mul_f32 v[126:127], v[96:97], v[124:125]
    v_pk_mul_f32 v[128:129], v[98:99], v[124:125]
    v_pk_mul_f32 v[130:131], v[100:101], v[124:125]
    v_pk_mul_f32 v[132:133], v[102:103], v[124:125]
    v_pk_mul_f32 v[134:135], v[104:105], v[124:125]
    v_pk_mul_f32 v[136:137], v[106:107], v[124:125]
    v_pk_mul_f32 v[138:139], v[108:109], v[124:125]
    v_pk_mul_f32 v[140:141], v[110:111], v[124:125]
    v_pk_fma_f32 v[126:127], v[98:99], v[122:123], v[126:127]
    v_pk_fma_f32 v[128:129], v[100:101], v[122:123], v[128:129]
    v_pk_fma_f32 v[130:131], v[102:103], v[122:123], v[130:131]
    v_pk_fma_f32 v[132:133], v[104:105], v[122:123], v[132:133]
    v_pk_fma_f32 v[134:135], v[106:107], v[122:123], v[134:135]
    v_pk_fma_f32 v[136:137], v[108:109], v[122:123], v[136:137]
    v_pk_fma_f32 v[138:139], v[110:111], v[122:123], v[138:139]
    v_pk_fma_f32 v[140:141], v[112:113], v[122:123], v[140:141]
    v_pk_fma_f32 v[126:127], v[100:101], v[120:121], v[126:127]
    v_pk_fma_f32 v[128:129], v[102:103], v[120:121], v[128:129]
    v_pk_fma_f32 v[130:131], v[104:105], v[120:121], v[130:131]
    v_pk_fma_f32 v[132:133], v[106:107], v[120:121], v[132:133]
    v_pk_fma_f32 v[134:135], v[108:109], v[120:121], v[134:135]
    v_pk_fma_f32 v[136:137], v[110:111], v[120:121], v[136:137]
    v_pk_fma_f32 v[138:139], v[112:113], v[120:121], v[138:139]
    v_pk_fma_f32 v[140:141], v[114:115], v[120:121], v[140:141]
    v_pk_fma_f32 v[126:127], v[102:103], v[118:119], v[126:127]
    v_pk_fma_f32 v[128:129], v[104:105], v[118:119], v[128:129]
    v_pk_fma_f32 v[130:131], v[106:107], v[118:119], v[130:131]
    v_pk_fma_f32 v[132:133], v[108:109], v[118:119], v[132:133]
    v_pk_fma_f32 v[134:135], v[110:111], v[118:119], v[134:135]
    v_pk_fma_f32 v[136:137], v[112:113], v[118:119], v[136:137]
    v_pk_fma_f32 v[138:139], v[114:115], v[118:119], v[138:139]
    v_pk_fma_f32 v[140:141], v[116:117], v[118:119], v[140:141]
    v_cvt_pk_bf16_f32 v142, v126, v127
    v_cvt_pk_bf16_f32 v143, v128, v129
    v_cvt_pk_bf16_f32 v144, v130, v131
    v_cvt_pk_bf16_f32 v145, v132, v133
    v_cvt_pk_bf16_f32 v146, v134, v135
    v_cvt_pk_bf16_f32 v147, v136, v137
    v_cvt_pk_bf16_f32 v148, v138, v139
    v_cvt_pk_bf16_f32 v149, v140, v141
    v_lshlrev_b32 v126, 16, v142
    v_and_b32 v127, s51, v142
    v_lshlrev_b32 v128, 16, v143
    v_and_b32 v129, s51, v143
    v_lshlrev_b32 v130, 16, v144
    v_and_b32 v131, s51, v144
    v_lshlrev_b32 v132, 16, v145
    v_and_b32 v133, s51, v145
    v_lshlrev_b32 v134, 16, v146
    v_and_b32 v135, s51, v146
    v_lshlrev_b32 v136, 16, v147
    v_and_b32 v137, s51, v147
    v_lshlrev_b32 v138, 16, v148
    v_and_b32 v139, s51, v148
    v_lshlrev_b32 v140, 16, v149
    v_and_b32 v141, s51, v149
    s_waitcnt lgkmcnt(0)
    v_lshlrev_b32 v96, 16, v52
    v_and_b32 v97, s51, v52
    v_lshlrev_b32 v98, 16, v53
    v_and_b32 v99, s51, v53
    v_lshlrev_b32 v100, 16, v54
    v_and_b32 v101, s51, v54
    v_lshlrev_b32 v102, 16, v55
    v_and_b32 v103, s51, v55
    v_lshlrev_b32 v104, 16, v56
    v_and_b32 v105, s51, v56
    v_lshlrev_b32 v106, 16, v57
    v_and_b32 v107, s51, v57
    v_lshlrev_b32 v108, 16, v58
    v_and_b32 v109, s51, v58
    v_lshlrev_b32 v110, 16, v59
    v_and_b32_e64 v111, s51, v59
    v_pk_mul_f32 v[126:127], v[126:127], v[96:97]
    v_pk_mul_f32 v[128:129], v[128:129], v[98:99]
    v_pk_mul_f32 v[130:131], v[130:131], v[100:101]
    v_pk_mul_f32 v[132:133], v[132:133], v[102:103]
    v_pk_mul_f32 v[134:135], v[134:135], v[104:105]
    v_pk_mul_f32 v[136:137], v[136:137], v[106:107]
    v_pk_mul_f32 v[138:139], v[138:139], v[108:109]
    v_pk_mul_f32 v[140:141], v[140:141], v[110:111]
    v_cvt_pk_bf16_f32 v150, v140, v138
    v_cvt_pk_bf16_f32 v151, v136, v134
    v_cvt_pk_bf16_f32 v152, v132, v130
    v_cvt_pk_bf16_f32 v153, v128, v126
    v_cvt_pk_bf16_f32 v154, v141, v139
    v_cvt_pk_bf16_f32 v155, v137, v135
    v_cvt_pk_bf16_f32 v156, v133, v131
    v_cvt_pk_bf16_f32 v157, v129, v127
    ds_write_b128 v67, v[150:153]
    ds_write_b128 v67, v[154:157] offset:128
    s_waitcnt lgkmcnt(0)
    ds_read_b128 v[32:35], v68
    ds_read_b128 v[36:39], v69 offset:1024
    s_lshl_b32 s64, s68, 18
    s_lshl_b32 s3, s67, 7
    s_sub_u32 s64, s64, s3
    s_lshl_b32 s3, s48, 16
    s_add_u32 s64, s64, s3
    s_add_u32 s64, s64, 3968
    s_add_u32 s73, s64, 32768
    s_waitcnt lgkmcnt(0)
    buffer_store_dwordx4 v[32:35], v70, s[4:7], s64 offen sc1
    buffer_store_dwordx4 v[36:39], v70, s[4:7], s73 offen sc1
    v_lshlrev_b32 v237, 16, v237
    ds_write_b32 v9, v237 offset:256
    s_cmp_lg_u32 s60, 0
    s_cbranch_scc1 L_act_43
    s_lshl_b32 s65, s2, 3
    s_lshl_b32 s3, s58, 1
    s_add_u32 s65, s65, s3
    s_lshl_b32 s3, s65, 10
    buffer_load_dwordx4 v[160:163], v12, s[8:11], s3 offen
    buffer_load_dwordx4 v[164:167], v12, s[8:11], s3 offen offset:16
    s_waitcnt vmcnt(0)
    s_waitcnt vmcnt(0)
    s_lshl_b32 s72, s68, 10
    s_lshl_b32 s3, s48, 8
    s_add_u32 s72, s72, s3
    s_lshl_b32 s3, s67, 3
    s_add_u32 s72, s72, s3
    s_add_u32 s72, s72, 4329472
    v_mov_b32 v224, s52
    v_mov_b32 v225, s53
    v_mov_b32 v226, 0
    s_mov_b64 exec, 1
    buffer_store_dwordx2 v[224:225], v226, s[4:7], s72 offen sc1
    s_mov_b64 exec, -1
    v_mov_b32 v15, 8
    s_mov_b64 exec, 1
    ds_write_b32 v23, v15 offset:16
    s_mov_b64 exec, -1
    v_lshlrev_b32 v192, 16, v160
    v_and_b32 v193, s51, v160
    v_lshlrev_b32 v194, 16, v161
    v_and_b32 v195, s51, v161
    v_lshlrev_b32 v196, 16, v162
    v_and_b32 v197, s51, v162
    v_lshlrev_b32 v198, 16, v163
    v_and_b32 v199, s51, v163
    v_lshlrev_b32 v200, 16, v164
    v_and_b32 v201, s51, v164
    v_lshlrev_b32 v202, 16, v165
    v_and_b32 v203, s51, v165
    v_lshlrev_b32 v204, 16, v166
    v_and_b32 v205, s51, v166
    v_lshlrev_b32 v206, 16, v167
    v_and_b32 v207, s51, v167
    v_add_f32 v208, v192, v196
    v_add_f32 v209, v193, v197
    v_add_f32 v210, v194, v198
    v_add_f32 v211, v195, v199
    v_add_f32 v208, v208, v200
    v_add_f32 v209, v209, v201
    v_add_f32 v210, v210, v202
    v_add_f32 v211, v211, v203
    v_add_f32 v208, v208, v204
    v_add_f32 v209, v209, v205
    v_add_f32 v210, v210, v206
    v_add_f32 v211, v211, v207
    v_add_f32 v208, v208, v209
    v_add_f32 v210, v210, v211
    v_add_f32 v208, v208, v210
    s_nop 1
    v_add_f32_dpp v208, v208, v208 row_shr:1 row_mask:0xf bank_mask:0xf bound_ctrl:0
    s_nop 1
    v_add_f32_dpp v208, v208, v208 row_shr:2 row_mask:0xf bank_mask:0xf bound_ctrl:0
    s_nop 1
    v_add_f32_dpp v208, v208, v208 row_shr:4 row_mask:0xf bank_mask:0xf bound_ctrl:0
    s_nop 1
    v_add_f32_dpp v208, v208, v208 row_shr:8 row_mask:0xf bank_mask:0xf bound_ctrl:0
    s_nop 1
    v_add_f32_dpp v208, v208, v208 row_bcast:15 row_mask:0xa bank_mask:0xf
    s_nop 0
    v_readlane_b32 s82, v208, 31
    v_readlane_b32 s83, v208, 63
    s_nop 0
    v_mov_b32 v208, s82
    s_mov_b32 exec_lo, 0
    v_mov_b32 v208, s83
    s_mov_b32 exec_lo, -1
    v_mul_f32 v212, 0x3b000000, v208
    v_sub_f32 v192, v192, v212
    v_sub_f32 v193, v193, v212
    v_sub_f32 v194, v194, v212
    v_sub_f32 v195, v195, v212
    v_sub_f32 v196, v196, v212
    v_sub_f32 v197, v197, v212
    v_sub_f32 v198, v198, v212
    v_sub_f32 v199, v199, v212
    v_sub_f32 v200, v200, v212
    v_sub_f32 v201, v201, v212
    v_sub_f32 v202, v202, v212
    v_sub_f32 v203, v203, v212
    v_sub_f32 v204, v204, v212
    v_sub_f32 v205, v205, v212
    v_sub_f32 v206, v206, v212
    v_sub_f32 v207, v207, v212
    v_mul_f32 v208, v192, v192
    v_mul_f32 v209, v193, v193
    v_mul_f32 v210, v194, v194
    v_mul_f32 v211, v195, v195
    v_fmac_f32 v208, v196, v196
    v_fmac_f32 v209, v197, v197
    v_fmac_f32 v210, v198, v198
    v_fmac_f32 v211, v199, v199
    v_fmac_f32 v208, v200, v200
    v_fmac_f32 v209, v201, v201
    v_fmac_f32 v210, v202, v202
    v_fmac_f32 v211, v203, v203
    v_fmac_f32 v208, v204, v204
    v_fmac_f32 v209, v205, v205
    v_fmac_f32 v210, v206, v206
    v_fmac_f32 v211, v207, v207
    v_add_f32 v208, v208, v209
    v_add_f32 v210, v210, v211
    v_add_f32 v208, v208, v210
    s_nop 1
    v_add_f32_dpp v208, v208, v208 row_shr:1 row_mask:0xf bank_mask:0xf bound_ctrl:0
    s_nop 1
    v_add_f32_dpp v208, v208, v208 row_shr:2 row_mask:0xf bank_mask:0xf bound_ctrl:0
    s_nop 1
    v_add_f32_dpp v208, v208, v208 row_shr:4 row_mask:0xf bank_mask:0xf bound_ctrl:0
    s_nop 1
    v_add_f32_dpp v208, v208, v208 row_shr:8 row_mask:0xf bank_mask:0xf bound_ctrl:0
    s_nop 1
    v_add_f32_dpp v208, v208, v208 row_bcast:15 row_mask:0xa bank_mask:0xf
    s_nop 0
    v_readlane_b32 s82, v208, 31
    v_readlane_b32 s83, v208, 63
    s_nop 0
    v_mov_b32 v208, s82
    s_mov_b32 exec_lo, 0
    v_mov_b32 v208, s83
    s_mov_b32 exec_lo, -1
    v_mul_f32 v213, 0x3b000000, v208
    v_cvt_pk_bf16_f32 v196, v212, v212
    v_lshlrev_b32 v196, 16, v196
    v_cvt_pk_bf16_f32 v214, v213, v213
    v_lshlrev_b32 v214, 16, v214
    v_add_f32 v214, 0x3727c5ac, v214
    v_cvt_pk_bf16_f32 v214, v214, v214
    v_lshlrev_b32 v214, 16, v214
    v_sqrt_f32 v214, v214
    s_nop 0
    v_cvt_pk_bf16_f32 v214, v214, v214
    v_lshlrev_b32 v214, 16, v214
    v_rcp_f32 v198, v214
    v_sub_f32 v215, v212, v196
    v_mul_f32 v216, v213, v198
    v_mul_f32 v215, v215, v198
    v_mul_f32 v216, v216, v198
    v_cvt_pk_bf16_f32 v215, v215, v215
    v_lshlrev_b32 v215, 16, v215
    v_cvt_pk_bf16_f32 v216, v216, v216
    v_lshlrev_b32 v216, 16, v216
    v_add_f32 v216, 0x3727c5ac, v216
    v_cvt_pk_bf16_f32 v216, v216, v216
    v_lshlrev_b32 v216, 16, v216
    v_sqrt_f32 v216, v216
    s_nop 0
    v_cvt_pk_bf16_f32 v216, v216, v216
    v_lshlrev_b32 v216, 16, v216
    v_rcp_f32 v216, v216
    v_fma_f32 v194, v196, v198, v215
    v_mov_b32 v193, s52
    v_mov_b32 v195, s53
    v_mov_b32 v197, s52
    v_mov_b32 v199, s53
    v_lshlrev_b32 v12, 5, v4
    v_mul_f32 v192, v198, v216
    v_mul_f32 v194, v194, v216
    v_sub_f32 v194, 0, v194
    s_lshl_b32 s64, s65, 5
    s_add_u32 s64, s64, 4194304
    s_mov_b32 exec_lo, 1
    s_mov_b32 exec_hi, 1
    buffer_store_dwordx4 v[192:195], v12, s[4:7], s64 offen sc1
    buffer_store_dwordx4 v[196:199], v12, s[4:7], s64 offen offset:16 sc1
    s_mov_b64 exec, -1
    v_mov_b32 v15, 1
    s_mov_b64 exec, 1
    ds_write_b32 v23, v15 offset:48
    s_mov_b64 exec, -1
    v_min_u32 v24, 13, v1
    v_lshlrev_b32 v24, 3, v24
    v_mov_b32 v238, 0
    v_mov_b32 v239, 0
    s_branch L_gs_44
L_act_43:
    ds_read_b128 v[240:243], v22
    s_waitcnt lgkmcnt(0)
    s_mov_b32 s3, 0
L_cs_45:
    v_min3_u32 v240, v240, v241, v242
    v_min_u32 v240, v240, v243
    v_cmp_gt_u32 vcc, 1, v240
    s_cbranch_vccz L_co_46
    s_add_u32 s3, s3, 1
    s_cmp_gt_u32 s3, 400000
    s_cbranch_scc1 L_co_46
    s_sleep 1
    ds_read_b128 v[240:243], v22
    s_waitcnt lgkmcnt(0)
    s_branch L_cs_45
L_co_46:
    s_nop 0
    ds_read_b128 v[96:99], v16 offset:0
    ds_read_b128 v[100:103], v16 offset:4096
    ds_read_b64_tr_b16 v[104:105], v20 offset:0
    ds_read_b64_tr_b16 v[106:107], v20 offset:1024
    ds_read_b64_tr_b16 v[108:109], v21 offset:0
    ds_read_b64_tr_b16 v[110:111], v21 offset:1024
    ds_read_b128 v[112:115], v17 offset:0
    ds_read_b128 v[116:119], v17 offset:4096
    ds_read_b64_tr_b16 v[120:121], v20 offset:4096
    ds_read_b64_tr_b16 v[122:123], v20 offset:5120
    ds_read_b64_tr_b16 v[124:125], v21 offset:4096
    ds_read_b64_tr_b16 v[126:127], v21 offset:5120
    ds_read_b128 v[128:131], v18 offset:0
    ds_read_b128 v[132:135], v18 offset:4096
    ds_read_b64_tr_b16 v[136:137], v20 offset:8192
    ds_read_b64_tr_b16 v[138:139], v20 offset:9216
    ds_read_b64_tr_b16 v[140:141], v21 offset:8192
    ds_read_b64_tr_b16 v[142:143], v21 offset:9216
    ds_read_b128 v[144:147], v19 offset:0
    ds_read_b128 v[148:151], v19 offset:4096
    ds_read_b64_tr_b16 v[152:153], v20 offset:12288
    ds_read_b64_tr_b16 v[154:155], v20 offset:13312
    ds_read_b64_tr_b16 v[156:157], v21 offset:12288
    ds_read_b64_tr_b16 v[158:159], v21 offset:13312
    ds_read_b128 v[240:243], v22
    s_waitcnt lgkmcnt(0)
    v_mov_b32 v15, 1
    s_mov_b64 exec, 1
    ds_write_b32 v23, v15 offset:16
    s_mov_b64 exec, -1
    s_mov_b32 s3, 0
L_cs_47:
    v_min3_u32 v240, v240, v241, v242
    v_min_u32 v240, v240, v243
    v_cmp_gt_u32 vcc, 2, v240
    s_cbranch_vccz L_co_48
    s_add_u32 s3, s3, 1
    s_cmp_gt_u32 s3, 400000
    s_cbranch_scc1 L_co_48
    s_sleep 1
    ds_read_b128 v[240:243], v22
    s_waitcnt lgkmcnt(0)
    s_branch L_cs_47
L_co_48:
    s_nop 0
    v_mfma_f32_32x32x16_bf16 v[32:47], v[104:107], v[96:99], 0
    ds_read_b128 v[160:163], v16 offset:32768
    v_mfma_f32_32x32x16_bf16 v[64:79], v[108:111], v[96:99], 0
    ds_read_b128 v[164:167], v16 offset:36864
    ds_read_b64_tr_b16 v[168:169], v20 offset:32768
    v_mfma_f32_32x32x16_bf16 v[48:63], v[104:107], v[100:103], 0
    ds_read_b64_tr_b16 v[170:171], v20 offset:33792
    ds_read_b64_tr_b16 v[172:173], v21 offset:32768
    v_mfma_f32_32x32x16_bf16 v[80:95], v[108:111], v[100:103], 0
    ds_read_b64_tr_b16 v[174:175], v21 offset:33792
    ds_read_b128 v[176:179], v17 offset:32768
    v_mfma_f32_32x32x16_bf16 v[32:47], v[120:123], v[112:115], v[32:47]
    ds_read_b128 v[180:183], v17 offset:36864
    ds_read_b64_tr_b16 v[184:185], v20 offset:36864
    v_mfma_f32_32x32x16_bf16 v[64:79], v[124:127], v[112:115], v[64:79]
    ds_read_b64_tr_b16 v[186:187], v20 offset:37888
    ds_read_b64_tr_b16 v[188:189], v21 offset:36864
    v_mfma_f32_32x32x16_bf16 v[48:63], v[120:123], v[116:119], v[48:63]
    ds_read_b64_tr_b16 v[190:191], v21 offset:37888
    ds_read_b128 v[192:195], v18 offset:32768
    v_mfma_f32_32x32x16_bf16 v[80:95], v[124:127], v[116:119], v[80:95]
    ds_read_b128 v[196:199], v18 offset:36864
    ds_read_b64_tr_b16 v[200:201], v20 offset:40960
    v_mfma_f32_32x32x16_bf16 v[32:47], v[136:139], v[128:131], v[32:47]
    ds_read_b64_tr_b16 v[202:203], v20 offset:41984
    ds_read_b64_tr_b16 v[204:205], v21 offset:40960
    v_mfma_f32_32x32x16_bf16 v[64:79], v[140:143], v[128:131], v[64:79]
    ds_read_b64_tr_b16 v[206:207], v21 offset:41984
    ds_read_b128 v[208:211], v19 offset:32768
    v_mfma_f32_32x32x16_bf16 v[48:63], v[136:139], v[132:135], v[48:63]
    ds_read_b128 v[212:215], v19 offset:36864
    ds_read_b64_tr_b16 v[216:217], v20 offset:45056
    v_mfma_f32_32x32x16_bf16 v[80:95], v[140:143], v[132:135], v[80:95]
    ds_read_b64_tr_b16 v[218:219], v20 offset:46080
    ds_read_b64_tr_b16 v[220:221], v21 offset:45056
    v_mfma_f32_32x32x16_bf16 v[32:47], v[152:155], v[144:147], v[32:47]
    ds_read_b64_tr_b16 v[222:223], v21 offset:46080
    ds_read_b128 v[240:243], v22
    v_mfma_f32_32x32x16_bf16 v[64:79], v[156:159], v[144:147], v[64:79]
    v_mfma_f32_32x32x16_bf16 v[48:63], v[152:155], v[148:151], v[48:63]
    v_mfma_f32_32x32x16_bf16 v[80:95], v[156:159], v[148:151], v[80:95]
    v_dot2_f32_bf16 v26, v104, v30, v26
    v_dot2_f32_bf16 v28, v108, v30, v28
    v_dot2_f32_bf16 v27, v120, v30, v27
    v_dot2_f32_bf16 v29, v124, v30, v29
    v_dot2_f32_bf16 v26, v136, v30, v26
    v_dot2_f32_bf16 v28, v140, v30, v28
    v_dot2_f32_bf16 v27, v152, v30, v27
    v_dot2_f32_bf16 v29, v156, v30, v29
    v_dot2_f32_bf16 v26, v105, v30, v26
    v_dot2_f32_bf16 v28, v109, v30, v28
    v_dot2_f32_bf16 v27, v121, v30, v27
    v_dot2_f32_bf16 v29, v125, v30, v29
    v_dot2_f32_bf16 v26, v137, v30, v26
    v_dot2_f32_bf16 v28, v141, v30, v28
    v_dot2_f32_bf16 v27, v153, v30, v27
    v_dot2_f32_bf16 v29, v157, v30, v29
    v_dot2_f32_bf16 v26, v106, v30, v26
    v_dot2_f32_bf16 v28, v110, v30, v28
    v_dot2_f32_bf16 v27, v122, v30, v27
    v_dot2_f32_bf16 v29, v126, v30, v29
    v_dot2_f32_bf16 v26, v138, v30, v26
    v_dot2_f32_bf16 v28, v142, v30, v28
    v_dot2_f32_bf16 v27, v154, v30, v27
    v_dot2_f32_bf16 v29, v158, v30, v29
    v_dot2_f32_bf16 v26, v107, v30, v26
    v_dot2_f32_bf16 v28, v111, v30, v28
    v_dot2_f32_bf16 v27, v123, v30, v27
    v_dot2_f32_bf16 v29, v127, v30, v29
    v_dot2_f32_bf16 v26, v139, v30, v26
    v_dot2_f32_bf16 v28, v143, v30, v28
    v_dot2_f32_bf16 v27, v155, v30, v27
    v_dot2_f32_bf16 v29, v159, v30, v29
    s_waitcnt lgkmcnt(0)
    s_waitcnt vmcnt(0)
    s_lshl_b32 s72, s68, 10
    s_lshl_b32 s3, s48, 8
    s_add_u32 s72, s72, s3
    s_lshl_b32 s3, s67, 3
    s_add_u32 s72, s72, s3
    s_add_u32 s72, s72, 4329472
    v_mov_b32 v224, s52
    v_mov_b32 v225, s53
    v_mov_b32 v226, 0
    s_mov_b64 exec, 1
    buffer_store_dwordx2 v[224:225], v226, s[4:7], s72 offen sc1
    s_mov_b64 exec, -1
    v_mov_b32 v15, 2
    s_mov_b64 exec, 1
    ds_write_b32 v23, v15 offset:16
    s_mov_b64 exec, -1
    s_mov_b32 s3, 0
L_cs_49:
    v_min3_u32 v240, v240, v241, v242
    v_min_u32 v240, v240, v243
    v_cmp_gt_u32 vcc, 3, v240
    s_cbranch_vccz L_co_50
    s_add_u32 s3, s3, 1
    s_cmp_gt_u32 s3, 400000
    s_cbranch_scc1 L_co_50
    s_sleep 1
    ds_read_b128 v[240:243], v22
    s_waitcnt lgkmcnt(0)
    s_branch L_cs_49
L_co_50:
    v_xor_b32 v16, 0x10000, v16
    v_xor_b32 v17, 0x10000, v17
    v_xor_b32 v18, 0x10000, v18
    v_xor_b32 v19, 0x10000, v19
    v_xor_b32 v20, 0x10000, v20
    v_xor_b32 v21, 0x10000, v21
    v_mfma_f32_32x32x16_bf16 v[32:47], v[168:171], v[160:163], v[32:47]
    ds_read_b128 v[96:99], v16 offset:0
    v_mfma_f32_32x32x16_bf16 v[64:79], v[172:175], v[160:163], v[64:79]
    ds_read_b128 v[100:103], v16 offset:4096
    ds_read_b64_tr_b16 v[104:105], v20 offset:0
    v_mfma_f32_32x32x16_bf16 v[48:63], v[168:171], v[164:167], v[48:63]
    ds_read_b64_tr_b16 v[106:107], v20 offset:1024
    ds_read_b64_tr_b16 v[108:109], v21 offset:0
    v_mfma_f32_32x32x16_bf16 v[80:95], v[172:175], v[164:167], v[80:95]
    ds_read_b64_tr_b16 v[110:111], v21 offset:1024
    ds_read_b128 v[112:115], v17 offset:0
    v_mfma_f32_32x32x16_bf16 v[32:47], v[184:187], v[176:179], v[32:47]
    ds_read_b128 v[116:119], v17 offset:4096
    ds_read_b64_tr_b16 v[120:121], v20 offset:4096
    v_mfma_f32_32x32x16_bf16 v[64:79], v[188:191], v[176:179], v[64:79]
    ds_read_b64_tr_b16 v[122:123], v20 offset:5120
    ds_read_b64_tr_b16 v[124:125], v21 offset:4096
    v_mfma_f32_32x32x16_bf16 v[48:63], v[184:187], v[180:183], v[48:63]
    ds_read_b64_tr_b16 v[126:127], v21 offset:5120
    ds_read_b128 v[128:131], v18 offset:0
    v_mfma_f32_32x32x16_bf16 v[80:95], v[188:191], v[180:183], v[80:95]
    ds_read_b128 v[132:135], v18 offset:4096
    ds_read_b64_tr_b16 v[136:137], v20 offset:8192
    v_mfma_f32_32x32x16_bf16 v[32:47], v[200:203], v[192:195], v[32:47]
    ds_read_b64_tr_b16 v[138:139], v20 offset:9216
    ds_read_b64_tr_b16 v[140:141], v21 offset:8192
    v_mfma_f32_32x32x16_bf16 v[64:79], v[204:207], v[192:195], v[64:79]
    ds_read_b64_tr_b16 v[142:143], v21 offset:9216
    ds_read_b128 v[144:147], v19 offset:0
    v_mfma_f32_32x32x16_bf16 v[48:63], v[200:203], v[196:199], v[48:63]
    ds_read_b128 v[148:151], v19 offset:4096
    ds_read_b64_tr_b16 v[152:153], v20 offset:12288
    v_mfma_f32_32x32x16_bf16 v[80:95], v[204:207], v[196:199], v[80:95]
    ds_read_b64_tr_b16 v[154:155], v20 offset:13312
    ds_read_b64_tr_b16 v[156:157], v21 offset:12288
    v_mfma_f32_32x32x16_bf16 v[32:47], v[216:219], v[208:211], v[32:47]
    ds_read_b64_tr_b16 v[158:159], v21 offset:13312
    ds_read_b128 v[240:243], v22
    v_mfma_f32_32x32x16_bf16 v[64:79], v[220:223], v[208:211], v[64:79]
    v_mfma_f32_32x32x16_bf16 v[48:63], v[216:219], v[212:215], v[48:63]
    v_mfma_f32_32x32x16_bf16 v[80:95], v[220:223], v[212:215], v[80:95]
    v_dot2_f32_bf16 v26, v168, v30, v26
    v_dot2_f32_bf16 v28, v172, v30, v28
    v_dot2_f32_bf16 v27, v184, v30, v27
    v_dot2_f32_bf16 v29, v188, v30, v29
    v_dot2_f32_bf16 v26, v200, v30, v26
    v_dot2_f32_bf16 v28, v204, v30, v28
    v_dot2_f32_bf16 v27, v216, v30, v27
    v_dot2_f32_bf16 v29, v220, v30, v29
    v_dot2_f32_bf16 v26, v169, v30, v26
    v_dot2_f32_bf16 v28, v173, v30, v28
    v_dot2_f32_bf16 v27, v185, v30, v27
    v_dot2_f32_bf16 v29, v189, v30, v29
    v_dot2_f32_bf16 v26, v201, v30, v26
    v_dot2_f32_bf16 v28, v205, v30, v28
    v_dot2_f32_bf16 v27, v217, v30, v27
    v_dot2_f32_bf16 v29, v221, v30, v29
    v_dot2_f32_bf16 v26, v170, v30, v26
    v_dot2_f32_bf16 v28, v174, v30, v28
    v_dot2_f32_bf16 v27, v186, v30, v27
    v_dot2_f32_bf16 v29, v190, v30, v29
    v_dot2_f32_bf16 v26, v202, v30, v26
    v_dot2_f32_bf16 v28, v206, v30, v28
    v_dot2_f32_bf16 v27, v218, v30, v27
    v_dot2_f32_bf16 v29, v222, v30, v29
    v_dot2_f32_bf16 v26, v171, v30, v26
    v_dot2_f32_bf16 v28, v175, v30, v28
    v_dot2_f32_bf16 v27, v187, v30, v27
    v_dot2_f32_bf16 v29, v191, v30, v29
    v_dot2_f32_bf16 v26, v203, v30, v26
    v_dot2_f32_bf16 v28, v207, v30, v28
    v_dot2_f32_bf16 v27, v219, v30, v27
    v_dot2_f32_bf16 v29, v223, v30, v29
    s_waitcnt lgkmcnt(0)
    v_mov_b32 v15, 3
    s_mov_b64 exec, 1
    ds_write_b32 v23, v15 offset:16
    s_mov_b64 exec, -1
    s_mov_b32 s3, 0
L_cs_51:
    v_min3_u32 v240, v240, v241, v242
    v_min_u32 v240, v240, v243
    v_cmp_gt_u32 vcc, 4, v240
    s_cbranch_vccz L_co_52
    s_add_u32 s3, s3, 1
    s_cmp_gt_u32 s3, 400000
    s_cbranch_scc1 L_co_52
    s_sleep 1
    ds_read_b128 v[240:243], v22
    s_waitcnt lgkmcnt(0)
    s_branch L_cs_51
L_co_52:
    s_nop 0
    v_mfma_f32_32x32x16_bf16 v[32:47], v[104:107], v[96:99], v[32:47]
    ds_read_b128 v[160:163], v16 offset:32768
    v_mfma_f32_32x32x16_bf16 v[64:79], v[108:111], v[96:99], v[64:79]
    ds_read_b128 v[164:167], v16 offset:36864
    ds_read_b64_tr_b16 v[168:169], v20 offset:32768
    v_mfma_f32_32x32x16_bf16 v[48:63], v[104:107], v[100:103], v[48:63]
    ds_read_b64_tr_b16 v[170:171], v20 offset:33792
    ds_read_b64_tr_b16 v[172:173], v21 offset:32768
    v_mfma_f32_32x32x16_bf16 v[80:95], v[108:111], v[100:103], v[80:95]
    ds_read_b64_tr_b16 v[174:175], v21 offset:33792
    ds_read_b128 v[176:179], v17 offset:32768
    v_mfma_f32_32x32x16_bf16 v[32:47], v[120:123], v[112:115], v[32:47]
    ds_read_b128 v[180:183], v17 offset:36864
    ds_read_b64_tr_b16 v[184:185], v20 offset:36864
    v_mfma_f32_32x32x16_bf16 v[64:79], v[124:127], v[112:115], v[64:79]
    ds_read_b64_tr_b16 v[186:187], v20 offset:37888
    ds_read_b64_tr_b16 v[188:189], v21 offset:36864
    v_mfma_f32_32x32x16_bf16 v[48:63], v[120:123], v[116:119], v[48:63]
    ds_read_b64_tr_b16 v[190:191], v21 offset:37888
    ds_read_b128 v[192:195], v18 offset:32768
    v_mfma_f32_32x32x16_bf16 v[80:95], v[124:127], v[116:119], v[80:95]
    ds_read_b128 v[196:199], v18 offset:36864
    ds_read_b64_tr_b16 v[200:201], v20 offset:40960
    v_mfma_f32_32x32x16_bf16 v[32:47], v[136:139], v[128:131], v[32:47]
    ds_read_b64_tr_b16 v[202:203], v20 offset:41984
    ds_read_b64_tr_b16 v[204:205], v21 offset:40960
    v_mfma_f32_32x32x16_bf16 v[64:79], v[140:143], v[128:131], v[64:79]
    ds_read_b64_tr_b16 v[206:207], v21 offset:41984
    ds_read_b128 v[208:211], v19 offset:32768
    v_mfma_f32_32x32x16_bf16 v[48:63], v[136:139], v[132:135], v[48:63]
    ds_read_b128 v[212:215], v19 offset:36864
    ds_read_b64_tr_b16 v[216:217], v20 offset:45056
    v_mfma_f32_32x32x16_bf16 v[80:95], v[140:143], v[132:135], v[80:95]
    ds_read_b64_tr_b16 v[218:219], v20 offset:46080
    ds_read_b64_tr_b16 v[220:221], v21 offset:45056
    v_mfma_f32_32x32x16_bf16 v[32:47], v[152:155], v[144:147], v[32:47]
    ds_read_b64_tr_b16 v[222:223], v21 offset:46080
    ds_read_b128 v[240:243], v22
    v_mfma_f32_32x32x16_bf16 v[64:79], v[156:159], v[144:147], v[64:79]
    v_mfma_f32_32x32x16_bf16 v[48:63], v[152:155], v[148:151], v[48:63]
    v_mfma_f32_32x32x16_bf16 v[80:95], v[156:159], v[148:151], v[80:95]
    v_dot2_f32_bf16 v26, v104, v30, v26
    v_dot2_f32_bf16 v28, v108, v30, v28
    v_dot2_f32_bf16 v27, v120, v30, v27
    v_dot2_f32_bf16 v29, v124, v30, v29
    v_dot2_f32_bf16 v26, v136, v30, v26
    v_dot2_f32_bf16 v28, v140, v30, v28
    v_dot2_f32_bf16 v27, v152, v30, v27
    v_dot2_f32_bf16 v29, v156, v30, v29
    v_dot2_f32_bf16 v26, v105, v30, v26
    v_dot2_f32_bf16 v28, v109, v30, v28
    v_dot2_f32_bf16 v27, v121, v30, v27
    v_dot2_f32_bf16 v29, v125, v30, v29
    v_dot2_f32_bf16 v26, v137, v30, v26
    v_dot2_f32_bf16 v28, v141, v30, v28
    v_dot2_f32_bf16 v27, v153, v30, v27
    v_dot2_f32_bf16 v29, v157, v30, v29
    v_dot2_f32_bf16 v26, v106, v30, v26
    v_dot2_f32_bf16 v28, v110, v30, v28
    v_dot2_f32_bf16 v27, v122, v30, v27
    v_dot2_f32_bf16 v29, v126, v30, v29
    v_dot2_f32_bf16 v26, v138, v30, v26
    v_dot2_f32_bf16 v28, v142, v30, v28
    v_dot2_f32_bf16 v27, v154, v30, v27
    v_dot2_f32_bf16 v29, v158, v30, v29
    v_dot2_f32_bf16 v26, v107, v30, v26
    v_dot2_f32_bf16 v28, v111, v30, v28
    v_dot2_f32_bf16 v27, v123, v30, v27
    v_dot2_f32_bf16 v29, v127, v30, v29
    v_dot2_f32_bf16 v26, v139, v30, v26
    v_dot2_f32_bf16 v28, v143, v30, v28
    v_dot2_f32_bf16 v27, v155, v30, v27
    v_dot2_f32_bf16 v29, v159, v30, v29
    s_waitcnt lgkmcnt(0)
    v_mov_b32 v15, 4
    s_mov_b64 exec, 1
    ds_write_b32 v23, v15 offset:16
    s_mov_b64 exec, -1
    s_mov_b32 s3, 0
L_cs_53:
    v_min3_u32 v240, v240, v241, v242
    v_min_u32 v240, v240, v243
    v_cmp_gt_u32 vcc, 5, v240
    s_cbranch_vccz L_co_54
    s_add_u32 s3, s3, 1
    s_cmp_gt_u32 s3, 400000
    s_cbranch_scc1 L_co_54
    s_sleep 1
    ds_read_b128 v[240:243], v22
    s_waitcnt lgkmcnt(0)
    s_branch L_cs_53
L_co_54:
    s_nop 0
    v_xor_b32 v16, 0x10000, v16
    v_xor_b32 v17, 0x10000, v17
    v_xor_b32 v18, 0x10000, v18
    v_xor_b32 v19, 0x10000, v19
    v_xor_b32 v20, 0x10000, v20
    v_xor_b32 v21, 0x10000, v21
    v_mfma_f32_32x32x16_bf16 v[32:47], v[168:171], v[160:163], v[32:47]
    ds_read_b128 v[96:99], v16 offset:0
    v_mfma_f32_32x32x16_bf16 v[64:79], v[172:175], v[160:163], v[64:79]
    ds_read_b128 v[100:103], v16 offset:4096
    ds_read_b64_tr_b16 v[104:105], v20 offset:0
    v_mfma_f32_32x32x16_bf16 v[48:63], v[168:171], v[164:167], v[48:63]
    ds_read_b64_tr_b16 v[106:107], v20 offset:1024
    ds_read_b64_tr_b16 v[108:109], v21 offset:0
    v_mfma_f32_32x32x16_bf16 v[80:95], v[172:175], v[164:167], v[80:95]
    ds_read_b64_tr_b16 v[110:111], v21 offset:1024
    ds_read_b128 v[112:115], v17 offset:0
    v_mfma_f32_32x32x16_bf16 v[32:47], v[184:187], v[176:179], v[32:47]
    ds_read_b128 v[116:119], v17 offset:4096
    ds_read_b64_tr_b16 v[120:121], v20 offset:4096
    v_mfma_f32_32x32x16_bf16 v[64:79], v[188:191], v[176:179], v[64:79]
    ds_read_b64_tr_b16 v[122:123], v20 offset:5120
    ds_read_b64_tr_b16 v[124:125], v21 offset:4096
    v_mfma_f32_32x32x16_bf16 v[48:63], v[184:187], v[180:183], v[48:63]
    ds_read_b64_tr_b16 v[126:127], v21 offset:5120
    ds_read_b128 v[128:131], v18 offset:0
    v_mfma_f32_32x32x16_bf16 v[80:95], v[188:191], v[180:183], v[80:95]
    ds_read_b128 v[132:135], v18 offset:4096
    ds_read_b64_tr_b16 v[136:137], v20 offset:8192
    v_mfma_f32_32x32x16_bf16 v[32:47], v[200:203], v[192:195], v[32:47]
    ds_read_b64_tr_b16 v[138:139], v20 offset:9216
    ds_read_b64_tr_b16 v[140:141], v21 offset:8192
    v_mfma_f32_32x32x16_bf16 v[64:79], v[204:207], v[192:195], v[64:79]
    ds_read_b64_tr_b16 v[142:143], v21 offset:9216
    ds_read_b128 v[144:147], v19 offset:0
    v_mfma_f32_32x32x16_bf16 v[48:63], v[200:203], v[196:199], v[48:63]
    ds_read_b128 v[148:151], v19 offset:4096
    ds_read_b64_tr_b16 v[152:153], v20 offset:12288
    v_mfma_f32_32x32x16_bf16 v[80:95], v[204:207], v[196:199], v[80:95]
    ds_read_b64_tr_b16 v[154:155], v20 offset:13312
    ds_read_b64_tr_b16 v[156:157], v21 offset:12288
    v_mfma_f32_32x32x16_bf16 v[32:47], v[216:219], v[208:211], v[32:47]
    ds_read_b64_tr_b16 v[158:159], v21 offset:13312
    ds_read_b128 v[240:243], v22
    v_mfma_f32_32x32x16_bf16 v[64:79], v[220:223], v[208:211], v[64:79]
    v_mfma_f32_32x32x16_bf16 v[48:63], v[216:219], v[212:215], v[48:63]
    v_mfma_f32_32x32x16_bf16 v[80:95], v[220:223], v[212:215], v[80:95]
    v_dot2_f32_bf16 v26, v168, v30, v26
    v_dot2_f32_bf16 v28, v172, v30, v28
    v_dot2_f32_bf16 v27, v184, v30, v27
    v_dot2_f32_bf16 v29, v188, v30, v29
    v_dot2_f32_bf16 v26, v200, v30, v26
    v_dot2_f32_bf16 v28, v204, v30, v28
    v_dot2_f32_bf16 v27, v216, v30, v27
    v_dot2_f32_bf16 v29, v220, v30, v29
    v_dot2_f32_bf16 v26, v169, v30, v26
    v_dot2_f32_bf16 v28, v173, v30, v28
    v_dot2_f32_bf16 v27, v185, v30, v27
    v_dot2_f32_bf16 v29, v189, v30, v29
    v_dot2_f32_bf16 v26, v201, v30, v26
    v_dot2_f32_bf16 v28, v205, v30, v28
    v_dot2_f32_bf16 v27, v217, v30, v27
    v_dot2_f32_bf16 v29, v221, v30, v29
    v_dot2_f32_bf16 v26, v170, v30, v26
    v_dot2_f32_bf16 v28, v174, v30, v28
    v_dot2_f32_bf16 v27, v186, v30, v27
    v_dot2_f32_bf16 v29, v190, v30, v29
    v_dot2_f32_bf16 v26, v202, v30, v26
    v_dot2_f32_bf16 v28, v206, v30, v28
    v_dot2_f32_bf16 v27, v218, v30, v27
    v_dot2_f32_bf16 v29, v222, v30, v29
    v_dot2_f32_bf16 v26, v171, v30, v26
    v_dot2_f32_bf16 v28, v175, v30, v28
    v_dot2_f32_bf16 v27, v187, v30, v27
    v_dot2_f32_bf16 v29, v191, v30, v29
    v_dot2_f32_bf16 v26, v203, v30, v26
    v_dot2_f32_bf16 v28, v207, v30, v28
    v_dot2_f32_bf16 v27, v219, v30, v27
    v_dot2_f32_bf16 v29, v223, v30, v29
    s_waitcnt lgkmcnt(0)
    s_mov_b32 s3, 0
L_cs_55:
    v_min3_u32 v240, v240, v241, v242
    v_min_u32 v240, v240, v243
    v_cmp_gt_u32 vcc, 6, v240
    s_cbranch_vccz L_co_56
    s_add_u32 s3, s3, 1
    s_cmp_gt_u32 s3, 400000
    s_cbranch_scc1 L_co_56
    s_sleep 1
    ds_read_b128 v[240:243], v22
    s_waitcnt lgkmcnt(0)
    s_branch L_cs_55
L_co_56:
    v_mfma_f32_32x32x16_bf16 v[32:47], v[104:107], v[96:99], v[32:47]
    ds_read_b128 v[160:163], v16 offset:32768
    v_mfma_f32_32x32x16_bf16 v[64:79], v[108:111], v[96:99], v[64:79]
    ds_read_b128 v[164:167], v16 offset:36864
    ds_read_b64_tr_b16 v[168:169], v20 offset:32768
    v_mfma_f32_32x32x16_bf16 v[48:63], v[104:107], v[100:103], v[48:63]
    ds_read_b64_tr_b16 v[170:171], v20 offset:33792
    ds_read_b64_tr_b16 v[172:173], v21 offset:32768
    v_mfma_f32_32x32x16_bf16 v[80:95], v[108:111], v[100:103], v[80:95]
    ds_read_b64_tr_b16 v[174:175], v21 offset:33792
    ds_read_b128 v[176:179], v17 offset:32768
    v_mfma_f32_32x32x16_bf16 v[32:47], v[120:123], v[112:115], v[32:47]
    ds_read_b128 v[180:183], v17 offset:36864
    ds_read_b64_tr_b16 v[184:185], v20 offset:36864
    v_mfma_f32_32x32x16_bf16 v[64:79], v[124:127], v[112:115], v[64:79]
    ds_read_b64_tr_b16 v[186:187], v20 offset:37888
    ds_read_b64_tr_b16 v[188:189], v21 offset:36864
    v_mfma_f32_32x32x16_bf16 v[48:63], v[120:123], v[116:119], v[48:63]
    ds_read_b64_tr_b16 v[190:191], v21 offset:37888
    ds_read_b128 v[192:195], v18 offset:32768
    v_mfma_f32_32x32x16_bf16 v[80:95], v[124:127], v[116:119], v[80:95]
    ds_read_b128 v[196:199], v18 offset:36864
    ds_read_b64_tr_b16 v[200:201], v20 offset:40960
    v_mfma_f32_32x32x16_bf16 v[32:47], v[136:139], v[128:131], v[32:47]
    ds_read_b64_tr_b16 v[202:203], v20 offset:41984
    ds_read_b64_tr_b16 v[204:205], v21 offset:40960
    v_mfma_f32_32x32x16_bf16 v[64:79], v[140:143], v[128:131], v[64:79]
    ds_read_b64_tr_b16 v[206:207], v21 offset:41984
    ds_read_b128 v[208:211], v19 offset:32768
    v_mfma_f32_32x32x16_bf16 v[48:63], v[136:139], v[132:135], v[48:63]
    ds_read_b128 v[212:215], v19 offset:36864
    ds_read_b64_tr_b16 v[216:217], v20 offset:45056
    v_mfma_f32_32x32x16_bf16 v[80:95], v[140:143], v[132:135], v[80:95]
    ds_read_b64_tr_b16 v[218:219], v20 offset:46080
    ds_read_b64_tr_b16 v[220:221], v21 offset:45056
    v_mfma_f32_32x32x16_bf16 v[32:47], v[152:155], v[144:147], v[32:47]
    ds_read_b64_tr_b16 v[222:223], v21 offset:46080
    ds_read_b128 v[240:243], v22
    v_mfma_f32_32x32x16_bf16 v[64:79], v[156:159], v[144:147], v[64:79]
    v_mfma_f32_32x32x16_bf16 v[48:63], v[152:155], v[148:151], v[48:63]
    v_mfma_f32_32x32x16_bf16 v[80:95], v[156:159], v[148:151], v[80:95]
    v_dot2_f32_bf16 v26, v104, v30, v26
    v_dot2_f32_bf16 v28, v108, v30, v28
    v_dot2_f32_bf16 v27, v120, v30, v27
    v_dot2_f32_bf16 v29, v124, v30, v29
    v_dot2_f32_bf16 v26, v136, v30, v26
    v_dot2_f32_bf16 v28, v140, v30, v28
    v_dot2_f32_bf16 v27, v152, v30, v27
    v_dot2_f32_bf16 v29, v156, v30, v29
    v_dot2_f32_bf16 v26, v105, v30, v26
    v_dot2_f32_bf16 v28, v109, v30, v28
    v_dot2_f32_bf16 v27, v121, v30, v27
    v_dot2_f32_bf16 v29, v125, v30, v29
    v_dot2_f32_bf16 v26, v137, v30, v26
    v_dot2_f32_bf16 v28, v141, v30, v28
    v_dot2_f32_bf16 v27, v153, v30, v27
    v_dot2_f32_bf16 v29, v157, v30, v29
    v_dot2_f32_bf16 v26, v106, v30, v26
    v_dot2_f32_bf16 v28, v110, v30, v28
    v_dot2_f32_bf16 v27, v122, v30, v27
    v_dot2_f32_bf16 v29, v126, v30, v29
    v_dot2_f32_bf16 v26, v138, v30, v26
    v_dot2_f32_bf16 v28, v142, v30, v28
    v_dot2_f32_bf16 v27, v154, v30, v27
    v_dot2_f32_bf16 v29, v158, v30, v29
    v_dot2_f32_bf16 v26, v107, v30, v26
    v_dot2_f32_bf16 v28, v111, v30, v28
    v_dot2_f32_bf16 v27, v123, v30, v27
    v_dot2_f32_bf16 v29, v127, v30, v29
    v_dot2_f32_bf16 v26, v139, v30, v26
    v_dot2_f32_bf16 v28, v143, v30, v28
    v_dot2_f32_bf16 v27, v155, v30, v27
    v_dot2_f32_bf16 v29, v159, v30, v29
    s_waitcnt lgkmcnt(0)
    v_mov_b32 v15, 6
    s_mov_b64 exec, 1
    ds_write_b32 v23, v15 offset:16
    s_mov_b64 exec, -1
    s_mov_b32 s3, 0
L_cs_57:
    v_min3_u32 v240, v240, v241, v242
    v_min_u32 v240, v240, v243
    v_cmp_gt_u32 vcc, 7, v240
    s_cbranch_vccz L_co_58
    s_add_u32 s3, s3, 1
    s_cmp_gt_u32 s3, 400000
    s_cbranch_scc1 L_co_58
    s_sleep 1
    ds_read_b128 v[240:243], v22
    s_waitcnt lgkmcnt(0)
    s_branch L_cs_57
L_co_58:
    s_nop 0
    v_xor_b32 v16, 0x10000, v16
    v_xor_b32 v17, 0x10000, v17
    v_xor_b32 v18, 0x10000, v18
    v_xor_b32 v19, 0x10000, v19
    v_xor_b32 v20, 0x10000, v20
    v_xor_b32 v21, 0x10000, v21
    v_mfma_f32_32x32x16_bf16 v[32:47], v[168:171], v[160:163], v[32:47]
    ds_read_b128 v[96:99], v16 offset:0
    v_mfma_f32_32x32x16_bf16 v[64:79], v[172:175], v[160:163], v[64:79]
    ds_read_b128 v[100:103], v16 offset:4096
    ds_read_b64_tr_b16 v[104:105], v20 offset:0
    v_mfma_f32_32x32x16_bf16 v[48:63], v[168:171], v[164:167], v[48:63]
    ds_read_b64_tr_b16 v[106:107], v20 offset:1024
    ds_read_b64_tr_b16 v[108:109], v21 offset:0
    v_mfma_f32_32x32x16_bf16 v[80:95], v[172:175], v[164:167], v[80:95]
    ds_read_b64_tr_b16 v[110:111], v21 offset:1024
    ds_read_b128 v[112:115], v17 offset:0
    v_mfma_f32_32x32x16_bf16 v[32:47], v[184:187], v[176:179], v[32:47]
    ds_read_b128 v[116:119], v17 offset:4096
    ds_read_b64_tr_b16 v[120:121], v20 offset:4096
    v_mfma_f32_32x32x16_bf16 v[64:79], v[188:191], v[176:179], v[64:79]
    ds_read_b64_tr_b16 v[122:123], v20 offset:5120
    ds_read_b64_tr_b16 v[124:125], v21 offset:4096
    v_mfma_f32_32x32x16_bf16 v[48:63], v[184:187], v[180:183], v[48:63]
    ds_read_b64_tr_b16 v[126:127], v21 offset:5120
    ds_read_b128 v[128:131], v18 offset:0
    v_mfma_f32_32x32x16_bf16 v[80:95], v[188:191], v[180:183], v[80:95]
    ds_read_b128 v[132:135], v18 offset:4096
    ds_read_b64_tr_b16 v[136:137], v20 offset:8192
    v_mfma_f32_32x32x16_bf16 v[32:47], v[200:203], v[192:195], v[32:47]
    ds_read_b64_tr_b16 v[138:139], v20 offset:9216
    ds_read_b64_tr_b16 v[140:141], v21 offset:8192
    v_mfma_f32_32x32x16_bf16 v[64:79], v[204:207], v[192:195], v[64:79]
    ds_read_b64_tr_b16 v[142:143], v21 offset:9216
    ds_read_b128 v[144:147], v19 offset:0
    v_mfma_f32_32x32x16_bf16 v[48:63], v[200:203], v[196:199], v[48:63]
    ds_read_b128 v[148:151], v19 offset:4096
    ds_read_b64_tr_b16 v[152:153], v20 offset:12288
    v_mfma_f32_32x32x16_bf16 v[80:95], v[204:207], v[196:199], v[80:95]
    ds_read_b64_tr_b16 v[154:155], v20 offset:13312
    ds_read_b64_tr_b16 v[156:157], v21 offset:12288
    v_mfma_f32_32x32x16_bf16 v[32:47], v[216:219], v[208:211], v[32:47]
    ds_read_b64_tr_b16 v[158:159], v21 offset:13312
    ds_read_b128 v[240:243], v22
    v_mfma_f32_32x32x16_bf16 v[64:79], v[220:223], v[208:211], v[64:79]
    v_mfma_f32_32x32x16_bf16 v[48:63], v[216:219], v[212:215], v[48:63]
    v_mfma_f32_32x32x16_bf16 v[80:95], v[220:223], v[212:215], v[80:95]
    v_dot2_f32_bf16 v26, v168, v30, v26
    v_dot2_f32_bf16 v28, v172, v30, v28
    v_dot2_f32_bf16 v27, v184, v30, v27
    v_dot2_f32_bf16 v29, v188, v30, v29
    v_dot2_f32_bf16 v26, v200, v30, v26
    v_dot2_f32_bf16 v28, v204, v30, v28
    v_dot2_f32_bf16 v27, v216, v30, v27
    v_dot2_f32_bf16 v29, v220, v30, v29
    v_dot2_f32_bf16 v26, v169, v30, v26
    v_dot2_f32_bf16 v28, v173, v30, v28
    v_dot2_f32_bf16 v27, v185, v30, v27
    v_dot2_f32_bf16 v29, v189, v30, v29
    v_dot2_f32_bf16 v26, v201, v30, v26
    v_dot2_f32_bf16 v28, v205, v30, v28
    v_dot2_f32_bf16 v27, v217, v30, v27
    v_dot2_f32_bf16 v29, v221, v30, v29
    v_dot2_f32_bf16 v26, v170, v30, v26
    v_dot2_f32_bf16 v28, v174, v30, v28
    v_dot2_f32_bf16 v27, v186, v30, v27
    v_dot2_f32_bf16 v29, v190, v30, v29
    v_dot2_f32_bf16 v26, v202, v30, v26
    v_dot2_f32_bf16 v28, v206, v30, v28
    v_dot2_f32_bf16 v27, v218, v30, v27
    v_dot2_f32_bf16 v29, v222, v30, v29
    v_dot2_f32_bf16 v26, v171, v30, v26
    v_dot2_f32_bf16 v28, v175, v30, v28
    v_dot2_f32_bf16 v27, v187, v30, v27
    v_dot2_f32_bf16 v29, v191, v30, v29
    v_dot2_f32_bf16 v26, v203, v30, v26
    v_dot2_f32_bf16 v28, v207, v30, v28
    v_dot2_f32_bf16 v27, v219, v30, v27
    v_dot2_f32_bf16 v29, v223, v30, v29
    s_waitcnt lgkmcnt(0)
    s_mov_b32 s3, 0
L_cs_59:
    v_min3_u32 v240, v240, v241, v242
    v_min_u32 v240, v240, v243
    v_cmp_gt_u32 vcc, 8, v240
    s_cbranch_vccz L_co_60
    s_add_u32 s3, s3, 1
    s_cmp_gt_u32 s3, 400000
    s_cbranch_scc1 L_co_60
    s_sleep 1
    ds_read_b128 v[240:243], v22
    s_waitcnt lgkmcnt(0)
    s_branch L_cs_59
L_co_60:
    buffer_load_dwordx4 v[224:227], v6, s[4:7], s77 offen sc1
    buffer_load_dwordx4 v[228:231], v6, s[4:7], s78 offen sc1
    v_mfma_f32_32x32x16_bf16 v[32:47], v[104:107], v[96:99], v[32:47]
    ds_read_b128 v[160:163], v16 offset:32768
    v_mfma_f32_32x32x16_bf16 v[64:79], v[108:111], v[96:99], v[64:79]
    ds_read_b128 v[164:167], v16 offset:36864
    ds_read_b64_tr_b16 v[168:169], v20 offset:32768
    v_mfma_f32_32x32x16_bf16 v[48:63], v[104:107], v[100:103], v[48:63]
    ds_read_b64_tr_b16 v[170:171], v20 offset:33792
    ds_read_b64_tr_b16 v[172:173], v21 offset:32768
    v_mfma_f32_32x32x16_bf16 v[80:95], v[108:111], v[100:103], v[80:95]
    ds_read_b64_tr_b16 v[174:175], v21 offset:33792
    ds_read_b128 v[176:179], v17 offset:32768
    v_mfma_f32_32x32x16_bf16 v[32:47], v[120:123], v[112:115], v[32:47]
    ds_read_b128 v[180:183], v17 offset:36864
    ds_read_b64_tr_b16 v[184:185], v20 offset:36864
    v_mfma_f32_32x32x16_bf16 v[64:79], v[124:127], v[112:115], v[64:79]
    ds_read_b64_tr_b16 v[186:187], v20 offset:37888
    ds_read_b64_tr_b16 v[188:189], v21 offset:36864
    v_mfma_f32_32x32x16_bf16 v[48:63], v[120:123], v[116:119], v[48:63]
    ds_read_b64_tr_b16 v[190:191], v21 offset:37888
    v_mfma_f32_32x32x16_bf16 v[80:95], v[124:127], v[116:119], v[80:95]
    ds_read_b128 v[192:195], v18 offset:32768
    ds_read_b128 v[196:199], v18 offset:36864
    v_mfma_f32_32x32x16_bf16 v[32:47], v[136:139], v[128:131], v[32:47]
    ds_read_b64_tr_b16 v[200:201], v20 offset:40960
    ds_read_b64_tr_b16 v[202:203], v20 offset:41984
    v_mfma_f32_32x32x16_bf16 v[64:79], v[140:143], v[128:131], v[64:79]
    ds_read_b64_tr_b16 v[204:205], v21 offset:40960
    ds_read_b64_tr_b16 v[206:207], v21 offset:41984
    v_mfma_f32_32x32x16_bf16 v[48:63], v[136:139], v[132:135], v[48:63]
    ds_read_b128 v[208:211], v19 offset:32768
    ds_read_b128 v[212:215], v19 offset:36864
    v_mfma_f32_32x32x16_bf16 v[80:95], v[140:143], v[132:135], v[80:95]
    ds_read_b64_tr_b16 v[216:217], v20 offset:45056
    ds_read_b64_tr_b16 v[218:219], v20 offset:46080
    v_mfma_f32_32x32x16_bf16 v[32:47], v[152:155], v[144:147], v[32:47]
    ds_read_b64_tr_b16 v[220:221], v21 offset:45056
    ds_read_b64_tr_b16 v[222:223], v21 offset:46080
    v_mfma_f32_32x32x16_bf16 v[64:79], v[156:159], v[144:147], v[64:79]
    v_mfma_f32_32x32x16_bf16 v[48:63], v[152:155], v[148:151], v[48:63]
    v_mfma_f32_32x32x16_bf16 v[80:95], v[156:159], v[148:151], v[80:95]
    v_dot2_f32_bf16 v26, v104, v30, v26
    v_dot2_f32_bf16 v28, v108, v30, v28
    v_dot2_f32_bf16 v27, v120, v30, v27
    v_dot2_f32_bf16 v29, v124, v30, v29
    v_dot2_f32_bf16 v26, v136, v30, v26
    v_dot2_f32_bf16 v28, v140, v30, v28
    v_dot2_f32_bf16 v27, v152, v30, v27
    v_dot2_f32_bf16 v29, v156, v30, v29
    v_dot2_f32_bf16 v26, v105, v30, v26
    v_dot2_f32_bf16 v28, v109, v30, v28
    v_dot2_f32_bf16 v27, v121, v30, v27
    v_dot2_f32_bf16 v29, v125, v30, v29
    v_dot2_f32_bf16 v26, v137, v30, v26
    v_dot2_f32_bf16 v28, v141, v30, v28
    v_dot2_f32_bf16 v27, v153, v30, v27
    v_dot2_f32_bf16 v29, v157, v30, v29
    v_dot2_f32_bf16 v26, v106, v30, v26
    v_dot2_f32_bf16 v28, v110, v30, v28
    v_dot2_f32_bf16 v27, v122, v30, v27
    v_dot2_f32_bf16 v29, v126, v30, v29
    v_dot2_f32_bf16 v26, v138, v30, v26
    v_dot2_f32_bf16 v28, v142, v30, v28
    v_dot2_f32_bf16 v27, v154, v30, v27
    v_dot2_f32_bf16 v29, v158, v30, v29
    v_dot2_f32_bf16 v26, v107, v30, v26
    v_dot2_f32_bf16 v28, v111, v30, v28
    v_dot2_f32_bf16 v27, v123, v30, v27
    v_dot2_f32_bf16 v29, v127, v30, v29
    v_dot2_f32_bf16 v26, v139, v30, v26
    v_dot2_f32_bf16 v28, v143, v30, v28
    v_dot2_f32_bf16 v27, v155, v30, v27
    v_dot2_f32_bf16 v29, v159, v30, v29
    s_waitcnt lgkmcnt(0)
    v_mov_b32 v15, 8
    s_mov_b64 exec, 1
    ds_write_b32 v23, v15 offset:16
    s_mov_b64 exec, -1
    v_dot2_f32_bf16 v26, v168, v30, v26
    v_dot2_f32_bf16 v28, v172, v30, v28
    v_dot2_f32_bf16 v27, v184, v30, v27
    v_dot2_f32_bf16 v29, v188, v30, v29
    v_dot2_f32_bf16 v26, v200, v30, v26
    v_dot2_f32_bf16 v28, v204, v30, v28
    v_dot2_f32_bf16 v27, v216, v30, v27
    v_dot2_f32_bf16 v29, v220, v30, v29
    v_dot2_f32_bf16 v26, v169, v30, v26
    v_dot2_f32_bf16 v28, v173, v30, v28
    v_dot2_f32_bf16 v27, v185, v30, v27
    v_dot2_f32_bf16 v29, v189, v30, v29
    v_dot2_f32_bf16 v26, v201, v30, v26
    v_dot2_f32_bf16 v28, v205, v30, v28
    v_dot2_f32_bf16 v27, v217, v30, v27
    v_dot2_f32_bf16 v29, v221, v30, v29
    v_dot2_f32_bf16 v26, v170, v30, v26
    v_dot2_f32_bf16 v28, v174, v30, v28
    v_dot2_f32_bf16 v27, v186, v30, v27
    v_dot2_f32_bf16 v29, v190, v30, v29
    v_dot2_f32_bf16 v26, v202, v30, v26
    v_dot2_f32_bf16 v28, v206, v30, v28
    v_dot2_f32_bf16 v27, v218, v30, v27
    v_dot2_f32_bf16 v29, v222, v30, v29
    v_dot2_f32_bf16 v26, v171, v30, v26
    v_dot2_f32_bf16 v28, v175, v30, v28
    v_dot2_f32_bf16 v27, v187, v30, v27
    v_dot2_f32_bf16 v29, v191, v30, v29
    v_dot2_f32_bf16 v26, v203, v30, v26
    v_dot2_f32_bf16 v28, v207, v30, v28
    v_dot2_f32_bf16 v27, v219, v30, v27
    v_dot2_f32_bf16 v29, v223, v30, v29
    s_nop 1
    v_add_f32 v26, v26, v27
    v_mov_b32 v27, v26
    s_nop 1
    v_permlane32_swap_b32 v26, v27
    v_add_f32 v26, v26, v27
    v_add_f32 v28, v28, v29
    v_mov_b32 v29, v28
    s_nop 1
    v_permlane32_swap_b32 v28, v29
    v_add_f32 v28, v28, v29
    v_lshlrev_b32 v5, 2, v3
    v_add_u32 v5, s76, v5
    ds_write_b32 v5, v26
    ds_write_b32 v5, v28 offset:128
    v_lshlrev_b32 v8, 4, v4
    v_add_u32 v8, s76, v8
    v_add_u32 v7, 128, v8
    s_waitcnt lgkmcnt(0)
    v_mfma_f32_32x32x16_bf16 v[32:47], v[168:171], v[160:163], v[32:47]
    ds_read_b128 v[96:99], v8 offset:0
    v_mfma_f32_32x32x16_bf16 v[64:79], v[172:175], v[160:163], v[64:79]
    ds_read_b128 v[112:115], v8 offset:256
    v_mfma_f32_32x32x16_bf16 v[48:63], v[168:171], v[164:167], v[48:63]
    v_mfma_f32_32x32x16_bf16 v[80:95], v[172:175], v[164:167], v[80:95]
    ds_read_b128 v[100:103], v8 offset:32
    v_mfma_f32_32x32x16_bf16 v[32:47], v[184:187], v[176:179], v[32:47]
    ds_read_b128 v[116:119], v8 offset:288
    v_mfma_f32_32x32x16_bf16 v[64:79], v[188:191], v[176:179], v[64:79]
    v_mfma_f32_32x32x16_bf16 v[48:63], v[184:187], v[180:183], v[48:63]
    ds_read_b128 v[104:107], v8 offset:64
    v_mfma_f32_32x32x16_bf16 v[80:95], v[188:191], v[180:183], v[80:95]
    v_mfma_f32_32x32x16_bf16 v[32:47], v[200:203], v[192:195], v[32:47]
    ds_read_b128 v[120:123], v8 offset:320
    v_mfma_f32_32x32x16_bf16 v[64:79], v[204:207], v[192:195], v[64:79]
    ds_read_b128 v[108:111], v8 offset:96
    v_mfma_f32_32x32x16_bf16 v[48:63], v[200:203], v[196:199], v[48:63]
    v_mfma_f32_32x32x16_bf16 v[80:95], v[204:207], v[196:199], v[80:95]
    ds_read_b128 v[124:127], v8 offset:352
    v_mfma_f32_32x32x16_bf16 v[32:47], v[216:219], v[208:211], v[32:47]
    v_mfma_f32_32x32x16_bf16 v[64:79], v[220:223], v[208:211], v[64:79]
    v_mfma_f32_32x32x16_bf16 v[48:63], v[216:219], v[212:215], v[48:63]
    v_mfma_f32_32x32x16_bf16 v[80:95], v[220:223], v[212:215], v[80:95]
    s_waitcnt vmcnt(0)
    s_mov_b32 s3, 0
L_spin_61:
    v_xor_b32 v225, s52, v225
    v_xor_b32 v227, s53, v227
    v_or_b32 v225, v225, v227
    v_cmp_ne_u32 vcc, 0, v225
    s_cbranch_vccz L_ok_62
    s_add_u32 s3, s3, 1
    s_cmp_gt_u32 s3, 20000
    s_cbranch_scc1 L_ok_62
    s_sleep 2
    buffer_load_dwordx4 v[224:227], v6, s[4:7], s77 offen sc1
    s_waitcnt vmcnt(0)
    s_branch L_spin_61
L_ok_62:
    s_mov_b32 s3, 0
L_spin_63:
    v_xor_b32 v229, s52, v229
    v_xor_b32 v231, s53, v231
    v_or_b32 v229, v229, v231
    v_cmp_ne_u32 vcc, 0, v229
    s_cbranch_vccz L_ok_64
    s_add_u32 s3, s3, 1
    s_cmp_gt_u32 s3, 20000
    s_cbranch_scc1 L_ok_64
    s_sleep 2
    buffer_load_dwordx4 v[228:231], v6, s[4:7], s78 offen sc1
    s_waitcnt vmcnt(0)
    s_branch L_spin_63
L_ok_64:
    v_mov_b32 v10, v224
    v_mov_b32 v11, v224
    v_mov_b32 v16, v226
    v_mov_b32 v17, v226
    v_mov_b32 v20, v228
    v_mov_b32 v21, v228
    v_mov_b32 v26, v230
    v_mov_b32 v27, v230
    v_mov_b32 v18, 0xc0135761
    v_mov_b32 v19, 0xc0135761
    s_mov_b32 s84, 0xbdd2d3e8
    s_mov_b32 s85, 0xbdd2d3e8
    s_mov_b32 s86, 1.0
    s_mov_b32 s87, 1.0
    s_lshl_b32 s75, s55, 2
    s_lshl_b32 s3, s70, 1
    s_add_u32 s75, s75, s3
    s_mul_i32 s75, s75, 112
    s_lshl_b32 s76, s56, 3
    s_add_u32 s75, s75, s76
    s_lshl_b32 s76, s71, 2
    s_add_u32 s75, s75, s76
    s_xor_b32 s76, s75, 2
    s_lshl_b32 s75, s75, 10
    s_add_u32 s75, s75, 5242880
    s_lshl_b32 s76, s76, 10
    s_nop 0
    s_add_u32 s76, s76, 5242880
    ds_read_b128 v[144:147], v7 offset:0
    ds_read_b128 v[160:163], v7 offset:256
    ds_read_b128 v[148:151], v7 offset:32
    ds_read_b128 v[164:167], v7 offset:288
    ds_read_b128 v[152:155], v7 offset:64
    ds_read_b128 v[168:171], v7 offset:320
    ds_read_b128 v[156:159], v7 offset:96
    ds_read_b128 v[172:175], v7 offset:352
    s_waitcnt lgkmcnt(8)
    s_nop 0
    v_pk_fma_f32 v[128:129], v[96:97], v[16:17], v[112:113]
    v_pk_fma_f32 v[130:131], v[98:99], v[16:17], v[114:115]
    v_pk_fma_f32 v[132:133], v[100:101], v[16:17], v[116:117]
    v_pk_fma_f32 v[134:135], v[102:103], v[16:17], v[118:119]
    v_pk_fma_f32 v[32:33], v[32:33], v[10:11], v[128:129]
    v_pk_fma_f32 v[34:35], v[34:35], v[10:11], v[130:131]
    v_pk_fma_f32 v[36:37], v[36:37], v[10:11], v[132:133]
    v_pk_fma_f32 v[38:39], v[38:39], v[10:11], v[134:135]
    v_pk_mul_f32 v[128:129], v[32:33], v[32:33]
    v_pk_mul_f32 v[130:131], v[34:35], v[34:35]
    v_pk_mul_f32 v[132:133], v[36:37], v[36:37]
    v_pk_mul_f32 v[134:135], v[38:39], v[38:39]
    v_pk_fma_f32 v[128:129], v[128:129], s[84:85], v[18:19]
    v_pk_fma_f32 v[130:131], v[130:131], s[84:85], v[18:19]
    v_pk_fma_f32 v[132:133], v[132:133], s[84:85], v[18:19]
    v_pk_fma_f32 v[134:135], v[134:135], s[84:85], v[18:19]
    v_pk_mul_f32 v[128:129], v[128:129], v[32:33]
    v_pk_mul_f32 v[130:131], v[130:131], v[34:35]
    v_pk_mul_f32 v[132:133], v[132:133], v[36:37]
    v_pk_mul_f32 v[134:135], v[134:135], v[38:39]
    v_exp_f32 v128, v128
    v_exp_f32 v129, v129
    v_exp_f32 v130, v130
    v_exp_f32 v131, v131
    v_exp_f32 v132, v132
    v_exp_f32 v133, v133
    v_exp_f32 v134, v134
    v_exp_f32 v135, v135
    v_pk_add_f32 v[128:129], v[128:129], s[86:87]
    v_pk_add_f32 v[130:131], v[130:131], s[86:87]
    v_pk_add_f32 v[132:133], v[132:133], s[86:87]
    v_pk_add_f32 v[134:135], v[134:135], s[86:87]
    v_rcp_f32 v128, v128
    v_rcp_f32 v129, v129
    v_rcp_f32 v130, v130
    v_rcp_f32 v131, v131
    v_rcp_f32 v132, v132
    v_rcp_f32 v133, v133
    v_rcp_f32 v134, v134
    v_rcp_f32 v135, v135
    v_pk_mul_f32 v[32:33], v[32:33], v[128:129]
    v_pk_mul_f32 v[34:35], v[34:35], v[130:131]
    v_pk_mul_f32 v[36:37], v[36:37], v[132:133]
    v_pk_mul_f32 v[38:39], v[38:39], v[134:135]
    v_cvt_pk_bf16_f32 v136, v32, v33
    v_cvt_pk_bf16_f32 v137, v34, v35
    v_cvt_pk_bf16_f32 v138, v36, v37
    v_cvt_pk_bf16_f32 v139, v38, v39
    s_add_u32 s3, s75, 0
    s_nop 0
    buffer_store_dwordx4 v[136:139], v13, s[4:7], s3 offen offset:0 sc1
    v_pk_fma_f32 v[128:129], v[104:105], v[16:17], v[120:121]
    v_pk_fma_f32 v[130:131], v[106:107], v[16:17], v[122:123]
    v_pk_fma_f32 v[132:133], v[108:109], v[16:17], v[124:125]
    v_pk_fma_f32 v[134:135], v[110:111], v[16:17], v[126:127]
    v_pk_fma_f32 v[40:41], v[40:41], v[10:11], v[128:129]
    v_pk_fma_f32 v[42:43], v[42:43], v[10:11], v[130:131]
    v_pk_fma_f32 v[44:45], v[44:45], v[10:11], v[132:133]
    v_pk_fma_f32 v[46:47], v[46:47], v[10:11], v[134:135]
    v_pk_mul_f32 v[128:129], v[40:41], v[40:41]
    v_pk_mul_f32 v[130:131], v[42:43], v[42:43]
    v_pk_mul_f32 v[132:133], v[44:45], v[44:45]
    v_pk_mul_f32 v[134:135], v[46:47], v[46:47]
    v_pk_fma_f32 v[128:129], v[128:129], s[84:85], v[18:19]
    v_pk_fma_f32 v[130:131], v[130:131], s[84:85], v[18:19]
    v_pk_fma_f32 v[132:133], v[132:133], s[84:85], v[18:19]
    v_pk_fma_f32 v[134:135], v[134:135], s[84:85], v[18:19]
    v_pk_mul_f32 v[128:129], v[128:129], v[40:41]
    v_pk_mul_f32 v[130:131], v[130:131], v[42:43]
    v_pk_mul_f32 v[132:133], v[132:133], v[44:45]
    v_pk_mul_f32 v[134:135], v[134:135], v[46:47]
    v_exp_f32 v128, v128
    v_exp_f32 v129, v129
    v_exp_f32 v130, v130
    v_exp_f32 v131, v131
    v_exp_f32 v132, v132
    v_exp_f32 v133, v133
    v_exp_f32 v134, v134
    v_exp_f32 v135, v135
    v_pk_add_f32 v[128:129], v[128:129], s[86:87]
    v_pk_add_f32 v[130:131], v[130:131], s[86:87]
    v_pk_add_f32 v[132:133], v[132:133], s[86:87]
    v_pk_add_f32 v[134:135], v[134:135], s[86:87]
    v_rcp_f32 v128, v128
    v_rcp_f32 v129, v129
    v_rcp_f32 v130, v130
    v_rcp_f32 v131, v131
    v_rcp_f32 v132, v132
    v_rcp_f32 v133, v133
    v_rcp_f32 v134, v134
    v_rcp_f32 v135, v135
    v_pk_mul_f32 v[40:41], v[40:41], v[128:129]
    v_pk_mul_f32 v[42:43], v[42:43], v[130:131]
    v_pk_mul_f32 v[44:45], v[44:45], v[132:133]
    v_pk_mul_f32 v[46:47], v[46:47], v[134:135]
    v_cvt_pk_bf16_f32 v140, v40, v41
    v_cvt_pk_bf16_f32 v141, v42, v43
    v_cvt_pk_bf16_f32 v142, v44, v45
    v_cvt_pk_bf16_f32 v143, v46, v47
    s_add_u32 s3, s75, 0
    s_nop 0
    buffer_store_dwordx4 v[140:143], v13, s[4:7], s3 offen offset:1024 sc1
    v_pk_fma_f32 v[128:129], v[96:97], v[26:27], v[112:113]
    v_pk_fma_f32 v[130:131], v[98:99], v[26:27], v[114:115]
    v_pk_fma_f32 v[132:133], v[100:101], v[26:27], v[116:117]
    v_pk_fma_f32 v[134:135], v[102:103], v[26:27], v[118:119]
    v_pk_fma_f32 v[48:49], v[48:49], v[20:21], v[128:129]
    v_pk_fma_f32 v[50:51], v[50:51], v[20:21], v[130:131]
    v_pk_fma_f32 v[52:53], v[52:53], v[20:21], v[132:133]
    v_pk_fma_f32 v[54:55], v[54:55], v[20:21], v[134:135]
    v_pk_mul_f32 v[128:129], v[48:49], v[48:49]
    v_pk_mul_f32 v[130:131], v[50:51], v[50:51]
    v_pk_mul_f32 v[132:133], v[52:53], v[52:53]
    v_pk_mul_f32 v[134:135], v[54:55], v[54:55]
    v_pk_fma_f32 v[128:129], v[128:129], s[84:85], v[18:19]
    v_pk_fma_f32 v[130:131], v[130:131], s[84:85], v[18:19]
    v_pk_fma_f32 v[132:133], v[132:133], s[84:85], v[18:19]
    v_pk_fma_f32 v[134:135], v[134:135], s[84:85], v[18:19]
    v_pk_mul_f32 v[128:129], v[128:129], v[48:49]
    v_pk_mul_f32 v[130:131], v[130:131], v[50:51]
    v_pk_mul_f32 v[132:133], v[132:133], v[52:53]
    v_pk_mul_f32 v[134:135], v[134:135], v[54:55]
    v_exp_f32 v128, v128
    v_exp_f32 v129, v129
    v_exp_f32 v130, v130
    v_exp_f32 v131, v131
    v_exp_f32 v132, v132
    v_exp_f32 v133, v133
    v_exp_f32 v134, v134
    v_exp_f32 v135, v135
    v_pk_add_f32 v[128:129], v[128:129], s[86:87]
    v_pk_add_f32 v[130:131], v[130:131], s[86:87]
    v_pk_add_f32 v[132:133], v[132:133], s[86:87]
    v_pk_add_f32 v[134:135], v[134:135], s[86:87]
    v_rcp_f32 v128, v128
    v_rcp_f32 v129, v129
    v_rcp_f32 v130, v130
    v_rcp_f32 v131, v131
    v_rcp_f32 v132, v132
    v_rcp_f32 v133, v133
    v_rcp_f32 v134, v134
    v_rcp_f32 v135, v135
    v_pk_mul_f32 v[48:49], v[48:49], v[128:129]
    v_pk_mul_f32 v[50:51], v[50:51], v[130:131]
    v_pk_mul_f32 v[52:53], v[52:53], v[132:133]
    v_pk_mul_f32 v[54:55], v[54:55], v[134:135]
    v_cvt_pk_bf16_f32 v136, v48, v49
    v_cvt_pk_bf16_f32 v137, v50, v51
    v_cvt_pk_bf16_f32 v138, v52, v53
    v_cvt_pk_bf16_f32 v139, v54, v55
    s_add_u32 s3, s75, 114688
    buffer_store_dwordx4 v[136:139], v13, s[4:7], s3 offen offset:0 sc1
    v_pk_fma_f32 v[128:129], v[104:105], v[26:27], v[120:121]
    v_pk_fma_f32 v[130:131], v[106:107], v[26:27], v[122:123]
    v_pk_fma_f32 v[132:133], v[108:109], v[26:27], v[124:125]
    v_pk_fma_f32 v[134:135], v[110:111], v[26:27], v[126:127]
    v_pk_fma_f32 v[56:57], v[56:57], v[20:21], v[128:129]
    v_pk_fma_f32 v[58:59], v[58:59], v[20:21], v[130:131]
    v_pk_fma_f32 v[60:61], v[60:61], v[20:21], v[132:133]
    v_pk_fma_f32 v[62:63], v[62:63], v[20:21], v[134:135]
    v_pk_mul_f32 v[128:129], v[56:57], v[56:57]
    v_pk_mul_f32 v[130:131], v[58:59], v[58:59]
    v_pk_mul_f32 v[132:133], v[60:61], v[60:61]
    v_pk_mul_f32 v[134:135], v[62:63], v[62:63]
    v_pk_fma_f32 v[128:129], v[128:129], s[84:85], v[18:19]
    v_pk_fma_f32 v[130:131], v[130:131], s[84:85], v[18:19]
    v_pk_fma_f32 v[132:133], v[132:133], s[84:85], v[18:19]
    v_pk_fma_f32 v[134:135], v[134:135], s[84:85], v[18:19]
    v_pk_mul_f32 v[128:129], v[128:129], v[56:57]
    v_pk_mul_f32 v[130:131], v[130:131], v[58:59]
    v_pk_mul_f32 v[132:133], v[132:133], v[60:61]
    v_pk_mul_f32 v[134:135], v[134:135], v[62:63]
    v_exp_f32 v128, v128
    v_exp_f32 v129, v129
    v_exp_f32 v130, v130
    v_exp_f32 v131, v131
    v_exp_f32 v132, v132
    v_exp_f32 v133, v133
    v_exp_f32 v134, v134
    v_exp_f32 v135, v135
    v_pk_add_f32 v[128:129], v[128:129], s[86:87]
    v_pk_add_f32 v[130:131], v[130:131], s[86:87]
    v_pk_add_f32 v[132:133], v[132:133], s[86:87]
    v_pk_add_f32 v[134:135], v[134:135], s[86:87]
    v_rcp_f32 v128, v128
    v_rcp_f32 v129, v129
    v_rcp_f32 v130, v130
    v_rcp_f32 v131, v131
    v_rcp_f32 v132, v132
    v_rcp_f32 v133, v133
    v_rcp_f32 v134, v134
    v_rcp_f32 v135, v135
    v_pk_mul_f32 v[56:57], v[56:57], v[128:129]
    v_pk_mul_f32 v[58:59], v[58:59], v[130:131]
    v_pk_mul_f32 v[60:61], v[60:61], v[132:133]
    v_pk_mul_f32 v[62:63], v[62:63], v[134:135]
    v_cvt_pk_bf16_f32 v140, v56, v57
    v_cvt_pk_bf16_f32 v141, v58, v59
    v_cvt_pk_bf16_f32 v142, v60, v61
    v_cvt_pk_bf16_f32 v143, v62, v63
    s_add_u32 s3, s75, 114688
    buffer_store_dwordx4 v[140:143], v13, s[4:7], s3 offen offset:1024 sc1
    s_waitcnt lgkmcnt(0)
    s_nop 0
    v_pk_fma_f32 v[128:129], v[144:145], v[16:17], v[160:161]
    v_pk_fma_f32 v[130:131], v[146:147], v[16:17], v[162:163]
    v_pk_fma_f32 v[132:133], v[148:149], v[16:17], v[164:165]
    v_pk_fma_f32 v[134:135], v[150:151], v[16:17], v[166:167]
    v_pk_fma_f32 v[64:65], v[64:65], v[10:11], v[128:129]
    v_pk_fma_f32 v[66:67], v[66:67], v[10:11], v[130:131]
    v_pk_fma_f32 v[68:69], v[68:69], v[10:11], v[132:133]
    v_pk_fma_f32 v[70:71], v[70:71], v[10:11], v[134:135]
    v_pk_mul_f32 v[128:129], v[64:65], v[64:65]
    v_pk_mul_f32 v[130:131], v[66:67], v[66:67]
    v_pk_mul_f32 v[132:133], v[68:69], v[68:69]
    v_pk_mul_f32 v[134:135], v[70:71], v[70:71]
    v_pk_fma_f32 v[128:129], v[128:129], s[84:85], v[18:19]
    v_pk_fma_f32 v[130:131], v[130:131], s[84:85], v[18:19]
    v_pk_fma_f32 v[132:133], v[132:133], s[84:85], v[18:19]
    v_pk_fma_f32 v[134:135], v[134:135], s[84:85], v[18:19]
    v_pk_mul_f32 v[128:129], v[128:129], v[64:65]
    v_pk_mul_f32 v[130:131], v[130:131], v[66:67]
    v_pk_mul_f32 v[132:133], v[132:133], v[68:69]
    v_pk_mul_f32 v[134:135], v[134:135], v[70:71]
    v_exp_f32 v128, v128
    v_exp_f32 v129, v129
    v_exp_f32 v130, v130
    v_exp_f32 v131, v131
    v_exp_f32 v132, v132
    v_exp_f32 v133, v133
    v_exp_f32 v134, v134
    v_exp_f32 v135, v135
    v_pk_add_f32 v[128:129], v[128:129], s[86:87]
    v_pk_add_f32 v[130:131], v[130:131], s[86:87]
    v_pk_add_f32 v[132:133], v[132:133], s[86:87]
    v_pk_add_f32 v[134:135], v[134:135], s[86:87]
    v_rcp_f32 v128, v128
    v_rcp_f32 v129, v129
    v_rcp_f32 v130, v130
    v_rcp_f32 v131, v131
    v_rcp_f32 v132, v132
    v_rcp_f32 v133, v133
    v_rcp_f32 v134, v134
    v_rcp_f32 v135, v135
    v_pk_mul_f32 v[64:65], v[64:65], v[128:129]
    v_pk_mul_f32 v[66:67], v[66:67], v[130:131]
    v_pk_mul_f32 v[68:69], v[68:69], v[132:133]
    v_pk_mul_f32 v[70:71], v[70:71], v[134:135]
    v_cvt_pk_bf16_f32 v136, v64, v65
    v_cvt_pk_bf16_f32 v137, v66, v67
    v_cvt_pk_bf16_f32 v138, v68, v69
    v_cvt_pk_bf16_f32 v139, v70, v71
    s_add_u32 s3, s76, 0
    s_nop 0
    buffer_store_dwordx4 v[136:139], v13, s[4:7], s3 offen offset:0 sc1
    v_pk_fma_f32 v[128:129], v[152:153], v[16:17], v[168:169]
    v_pk_fma_f32 v[130:131], v[154:155], v[16:17], v[170:171]
    v_pk_fma_f32 v[132:133], v[156:157], v[16:17], v[172:173]
    v_pk_fma_f32 v[134:135], v[158:159], v[16:17], v[174:175]
    v_pk_fma_f32 v[72:73], v[72:73], v[10:11], v[128:129]
    v_pk_fma_f32 v[74:75], v[74:75], v[10:11], v[130:131]
    v_pk_fma_f32 v[76:77], v[76:77], v[10:11], v[132:133]
    v_pk_fma_f32 v[78:79], v[78:79], v[10:11], v[134:135]
    v_pk_mul_f32 v[128:129], v[72:73], v[72:73]
    v_pk_mul_f32 v[130:131], v[74:75], v[74:75]
    v_pk_mul_f32 v[132:133], v[76:77], v[76:77]
    v_pk_mul_f32 v[134:135], v[78:79], v[78:79]
    v_pk_fma_f32 v[128:129], v[128:129], s[84:85], v[18:19]
    v_pk_fma_f32 v[130:131], v[130:131], s[84:85], v[18:19]
    v_pk_fma_f32 v[132:133], v[132:133], s[84:85], v[18:19]
    v_pk_fma_f32 v[134:135], v[134:135], s[84:85], v[18:19]
    v_pk_mul_f32 v[128:129], v[128:129], v[72:73]
    v_pk_mul_f32 v[130:131], v[130:131], v[74:75]
    v_pk_mul_f32 v[132:133], v[132:133], v[76:77]
    v_pk_mul_f32 v[134:135], v[134:135], v[78:79]
    v_exp_f32 v128, v128
    v_exp_f32 v129, v129
    v_exp_f32 v130, v130
    v_exp_f32 v131, v131
    v_exp_f32 v132, v132
    v_exp_f32 v133, v133
    v_exp_f32 v134, v134
    v_exp_f32 v135, v135
    v_pk_add_f32 v[128:129], v[128:129], s[86:87]
    v_pk_add_f32 v[130:131], v[130:131], s[86:87]
    v_pk_add_f32 v[132:133], v[132:133], s[86:87]
    v_pk_add_f32 v[134:135], v[134:135], s[86:87]
    v_rcp_f32 v128, v128
    v_rcp_f32 v129, v129
    v_rcp_f32 v130, v130
    v_rcp_f32 v131, v131
    v_rcp_f32 v132, v132
    v_rcp_f32 v133, v133
    v_rcp_f32 v134, v134
    v_rcp_f32 v135, v135
    v_pk_mul_f32 v[72:73], v[72:73], v[128:129]
    v_pk_mul_f32 v[74:75], v[74:75], v[130:131]
    v_pk_mul_f32 v[76:77], v[76:77], v[132:133]
    v_pk_mul_f32 v[78:79], v[78:79], v[134:135]
    v_cvt_pk_bf16_f32 v140, v72, v73
    v_cvt_pk_bf16_f32 v141, v74, v75
    v_cvt_pk_bf16_f32 v142, v76, v77
    v_cvt_pk_bf16_f32 v143, v78, v79
    s_add_u32 s3, s76, 0
    s_nop 0
    buffer_store_dwordx4 v[140:143], v13, s[4:7], s3 offen offset:1024 sc1
    v_pk_fma_f32 v[128:129], v[144:145], v[26:27], v[160:161]
    v_pk_fma_f32 v[130:131], v[146:147], v[26:27], v[162:163]
    v_pk_fma_f32 v[132:133], v[148:149], v[26:27], v[164:165]
    v_pk_fma_f32 v[134:135], v[150:151], v[26:27], v[166:167]
    v_pk_fma_f32 v[80:81], v[80:81], v[20:21], v[128:129]
    v_pk_fma_f32 v[82:83], v[82:83], v[20:21], v[130:131]
    v_pk_fma_f32 v[84:85], v[84:85], v[20:21], v[132:133]
    v_pk_fma_f32 v[86:87], v[86:87], v[20:21], v[134:135]
    v_pk_mul_f32 v[128:129], v[80:81], v[80:81]
    v_pk_mul_f32 v[130:131], v[82:83], v[82:83]
    v_pk_mul_f32 v[132:133], v[84:85], v[84:85]
    v_pk_mul_f32 v[134:135], v[86:87], v[86:87]
    v_pk_fma_f32 v[128:129], v[128:129], s[84:85], v[18:19]
    v_pk_fma_f32 v[130:131], v[130:131], s[84:85], v[18:19]
    v_pk_fma_f32 v[132:133], v[132:133], s[84:85], v[18:19]
    v_pk_fma_f32 v[134:135], v[134:135], s[84:85], v[18:19]
    v_pk_mul_f32 v[128:129], v[128:129], v[80:81]
    v_pk_mul_f32 v[130:131], v[130:131], v[82:83]
    v_pk_mul_f32 v[132:133], v[132:133], v[84:85]
    v_pk_mul_f32 v[134:135], v[134:135], v[86:87]
    v_exp_f32 v128, v128
    v_exp_f32 v129, v129
    v_exp_f32 v130, v130
    v_exp_f32 v131, v131
    v_exp_f32 v132, v132
    v_exp_f32 v133, v133
    v_exp_f32 v134, v134
    v_exp_f32 v135, v135
    v_pk_add_f32 v[128:129], v[128:129], s[86:87]
    v_pk_add_f32 v[130:131], v[130:131], s[86:87]
    v_pk_add_f32 v[132:133], v[132:133], s[86:87]
    v_pk_add_f32 v[134:135], v[134:135], s[86:87]
    v_rcp_f32 v128, v128
    v_rcp_f32 v129, v129
    v_rcp_f32 v130, v130
    v_rcp_f32 v131, v131
    v_rcp_f32 v132, v132
    v_rcp_f32 v133, v133
    v_rcp_f32 v134, v134
    v_rcp_f32 v135, v135
    v_pk_mul_f32 v[80:81], v[80:81], v[128:129]
    v_pk_mul_f32 v[82:83], v[82:83], v[130:131]
    v_pk_mul_f32 v[84:85], v[84:85], v[132:133]
    v_pk_mul_f32 v[86:87], v[86:87], v[134:135]
    v_cvt_pk_bf16_f32 v136, v80, v81
    v_cvt_pk_bf16_f32 v137, v82, v83
    v_cvt_pk_bf16_f32 v138, v84, v85
    v_cvt_pk_bf16_f32 v139, v86, v87
    s_add_u32 s3, s76, 114688
    buffer_store_dwordx4 v[136:139], v13, s[4:7], s3 offen offset:0 sc1
    v_pk_fma_f32 v[128:129], v[152:153], v[26:27], v[168:169]
    v_pk_fma_f32 v[130:131], v[154:155], v[26:27], v[170:171]
    v_pk_fma_f32 v[132:133], v[156:157], v[26:27], v[172:173]
    v_pk_fma_f32 v[134:135], v[158:159], v[26:27], v[174:175]
    v_pk_fma_f32 v[88:89], v[88:89], v[20:21], v[128:129]
    v_pk_fma_f32 v[90:91], v[90:91], v[20:21], v[130:131]
    v_pk_fma_f32 v[92:93], v[92:93], v[20:21], v[132:133]
    v_pk_fma_f32 v[94:95], v[94:95], v[20:21], v[134:135]
    v_pk_mul_f32 v[128:129], v[88:89], v[88:89]
    v_pk_mul_f32 v[130:131], v[90:91], v[90:91]
    v_pk_mul_f32 v[132:133], v[92:93], v[92:93]
    v_pk_mul_f32 v[134:135], v[94:95], v[94:95]
    v_pk_fma_f32 v[128:129], v[128:129], s[84:85], v[18:19]
    v_pk_fma_f32 v[130:131], v[130:131], s[84:85], v[18:19]
    v_pk_fma_f32 v[132:133], v[132:133], s[84:85], v[18:19]
    v_pk_fma_f32 v[134:135], v[134:135], s[84:85], v[18:19]
    v_pk_mul_f32 v[128:129], v[128:129], v[88:89]
    v_pk_mul_f32 v[130:131], v[130:131], v[90:91]
    v_pk_mul_f32 v[132:133], v[132:133], v[92:93]
    v_pk_mul_f32 v[134:135], v[134:135], v[94:95]
    v_exp_f32 v128, v128
    v_exp_f32 v129, v129
    v_exp_f32 v130, v130
    v_exp_f32 v131, v131
    v_exp_f32 v132, v132
    v_exp_f32 v133, v133
    v_exp_f32 v134, v134
    v_exp_f32 v135, v135
    v_pk_add_f32 v[128:129], v[128:129], s[86:87]
    v_pk_add_f32 v[130:131], v[130:131], s[86:87]
    v_pk_add_f32 v[132:133], v[132:133], s[86:87]
    v_pk_add_f32 v[134:135], v[134:135], s[86:87]
    v_rcp_f32 v128, v128
    v_rcp_f32 v129, v129
    v_rcp_f32 v130, v130
    v_rcp_f32 v131, v131
    v_rcp_f32 v132, v132
    v_rcp_f32 v133, v133
    v_rcp_f32 v134, v134
    v_rcp_f32 v135, v135
    v_pk_mul_f32 v[88:89], v[88:89], v[128:129]
    v_pk_mul_f32 v[90:91], v[90:91], v[130:131]
    v_pk_mul_f32 v[92:93], v[92:93], v[132:133]
    v_pk_mul_f32 v[94:95], v[94:95], v[134:135]
    v_cvt_pk_bf16_f32 v140, v88, v89
    v_cvt_pk_bf16_f32 v141, v90, v91
    v_cvt_pk_bf16_f32 v142, v92, v93
    v_cvt_pk_bf16_f32 v143, v94, v95
    s_add_u32 s3, s76, 114688
    buffer_store_dwordx4 v[140:143], v13, s[4:7], s3 offen offset:1024 sc1
    v_mov_b32 v15, 1
    s_mov_b64 exec, 1
    ds_write_b32 v23, v15 offset:48
    s_mov_b64 exec, -1
L_gs_44:
    s_lshl_b32 s72, s55, 1
    s_add_u32 s72, s72, s70
    s_lshl_b32 s72, s72, 8
    s_lshl_b32 s3, s56, 4
    s_add_u32 s72, s72, s3
    s_lshl_b32 s3, s71, 3
    s_add_u32 s72, s72, s3
    s_add_u32 s72, s72, 4349952
    s_lshl_b32 s80, s66, 11
    s_add_u32 s80, s80, s63
    s_add_u32 s81, s63, 32768
    s_waitcnt vmcnt(0)
    v_mov_b32 v16, s52
    v_mov_b32 v17, s53
    v_mov_b32 v18, 0
    s_mov_b64 exec, 1
    s_and_b32 exec_lo, s60, 1
    buffer_store_dwordx2 v[16:17], v18, s[4:7], s72 offen sc1
    s_mov_b64 exec, -1
    s_mov_b32 s3, 0
L_ws_65:
    ds_read_b32 v20, v31 offset:112
    s_waitcnt lgkmcnt(0)
    v_cmp_eq_u32 vcc, 0, v20
    s_cbranch_vccz L_wo_66
    s_add_u32 s3, s3, 1
    s_cmp_gt_u32 s3, 400000
    s_cbranch_scc1 L_wo_66
    s_sleep 4
    s_branch L_ws_65
L_wo_66:
    buffer_load_dwordx4 v[128:131], v13, s[4:7], s80 offen sc1
    buffer_load_dwordx4 v[132:135], v13, s[4:7], s80 offen offset:1024 sc1
    s_add_u32 s80, s80, 2048
    s_cmp_eq_u32 s80, s81
    s_cselect_b32 s80, s63, s80
    buffer_load_dwordx4 v[136:139], v13, s[4:7], s80 offen sc1
    buffer_load_dwordx4 v[140:143], v13, s[4:7], s80 offen offset:1024 sc1
    s_add_u32 s80, s80, 2048
    s_cmp_eq_u32 s80, s81
    s_cselect_b32 s80, s63, s80
    buffer_load_dwordx4 v[144:147], v13, s[4:7], s80 offen sc1
    buffer_load_dwordx4 v[148:151], v13, s[4:7], s80 offen offset:1024 sc1
    s_add_u32 s80, s80, 2048
    s_cmp_eq_u32 s80, s81
    s_cselect_b32 s80, s63, s80
    buffer_load_dwordx4 v[152:155], v13, s[4:7], s80 offen sc1
    buffer_load_dwordx4 v[156:159], v13, s[4:7], s80 offen offset:1024 sc1
    s_add_u32 s80, s80, 2048
    s_cmp_eq_u32 s80, s81
    s_cselect_b32 s80, s63, s80
    buffer_load_dwordx4 v[160:163], v13, s[4:7], s80 offen sc1
    buffer_load_dwordx4 v[164:167], v13, s[4:7], s80 offen offset:1024 sc1
    s_add_u32 s80, s80, 2048
    s_cmp_eq_u32 s80, s81
    s_cselect_b32 s80, s63, s80
    buffer_load_dwordx4 v[168:171], v13, s[4:7], s80 offen sc1
    buffer_load_dwordx4 v[172:175], v13, s[4:7], s80 offen offset:1024 sc1
    s_add_u32 s80, s80, 2048
    s_cmp_eq_u32 s80, s81
    s_cselect_b32 s80, s63, s80
    buffer_load_dwordx4 v[176:179], v13, s[4:7], s80 offen sc1
    buffer_load_dwordx4 v[180:183], v13, s[4:7], s80 offen offset:1024 sc1
    s_add_u32 s80, s80, 2048
    s_cmp_eq_u32 s80, s81
    s_cselect_b32 s80, s63, s80
    buffer_load_dwordx4 v[184:187], v13, s[4:7], s80 offen sc1
    buffer_load_dwordx4 v[188:191], v13, s[4:7], s80 offen offset:1024 sc1
    s_add_u32 s80, s80, 2048
    s_cmp_eq_u32 s80, s81
    s_cselect_b32 s80, s63, s80
    buffer_load_dwordx4 v[192:195], v13, s[4:7], s80 offen sc1
    buffer_load_dwordx4 v[196:199], v13, s[4:7], s80 offen offset:1024 sc1
    s_add_u32 s80, s80, 2048
    s_cmp_eq_u32 s80, s81
    s_cselect_b32 s80, s63, s80
    buffer_load_dwordx4 v[200:203], v13, s[4:7], s80 offen sc1
    buffer_load_dwordx4 v[204:207], v13, s[4:7], s80 offen offset:1024 sc1
    s_add_u32 s80, s80, 2048
    s_cmp_eq_u32 s80, s81
    s_cselect_b32 s80, s63, s80
    buffer_load_dwordx4 v[208:211], v13, s[4:7], s80 offen sc1
    buffer_load_dwordx4 v[212:215], v13, s[4:7], s80 offen offset:1024 sc1
    s_add_u32 s80, s80, 2048
    s_cmp_eq_u32 s80, s81
    s_cselect_b32 s80, s63, s80
    buffer_load_dwordx4 v[216:219], v13, s[4:7], s80 offen sc1
    buffer_load_dwordx4 v[220:223], v13, s[4:7], s80 offen offset:1024 sc1
    s_add_u32 s80, s80, 2048
    s_cmp_eq_u32 s80, s81
    s_cselect_b32 s80, s63, s80
    buffer_load_dwordx4 v[224:227], v13, s[4:7], s80 offen sc1
    buffer_load_dwordx4 v[228:231], v13, s[4:7], s80 offen offset:1024 sc1
    s_add_u32 s80, s80, 2048
    s_cmp_eq_u32 s80, s81
    s_cselect_b32 s80, s63, s80
    buffer_load_dwordx4 v[232:235], v13, s[4:7], s80 offen sc1
    buffer_load_dwordx4 v[236:239], v13, s[4:7], s80 offen offset:1024 sc1
    s_add_u32 s80, s80, 2048
    s_cmp_eq_u32 s80, s81
    s_cselect_b32 s80, s63, s80
    buffer_load_dwordx4 v[240:243], v13, s[4:7], s80 offen sc1
    buffer_load_dwordx4 v[244:247], v13, s[4:7], s80 offen offset:1024 sc1
    s_add_u32 s80, s80, 2048
    s_cmp_eq_u32 s80, s81
    s_cselect_b32 s80, s63, s80
    buffer_load_dwordx4 v[248:251], v13, s[4:7], s80 offen sc1
    buffer_load_dwordx4 v[252:255], v13, s[4:7], s80 offen offset:1024 sc1
    s_add_u32 s80, s80, 2048
    s_cmp_eq_u32 s80, s81
    s_cselect_b32 s80, s63, s80
    v_and_b32 v24, 7, v3
    s_lshl_b32 s84, s58, 13
    s_add_u32 s84, s84, 98304
    v_add_u32 v25, 0, v4
    v_xor_b32 v25, v25, v24
    v_lshl_add_u32 v25, v3, 3, v25
    v_lshlrev_b32 v25, 4, v25
    v_add_u32 v14, s84, v25
    v_add_u32 v25, 2, v4
    v_xor_b32 v25, v25, v24
    v_lshl_add_u32 v25, v3, 3, v25
    v_lshlrev_b32 v25, 4, v25
    v_add_u32 v15, s84, v25
    v_add_u32 v25, 4, v4
    v_xor_b32 v25, v25, v24
    v_lshl_add_u32 v25, v3, 3, v25
    v_lshlrev_b32 v25, 4, v25
    v_add_u32 v16, s84, v25
    v_add_u32 v25, 6, v4
    v_xor_b32 v25, v25, v24
    v_lshl_add_u32 v25, v3, 3, v25
    v_lshlrev_b32 v25, 4, v25
    v_add_u32 v17, s84, v25
    v_lshrrev_b32 v24, 3, v0
    v_and_b32 v25, 7, v0
    v_lshlrev_b32 v21, 10, v24
    v_lshlrev_b32 v22, 4, v25
    v_add_u32 v21, v21, v22
    v_lshlrev_b32 v23, 5, v24
    v_and_b32 v18, 7, v24
    v_xor_b32 v18, v18, v25
    v_and_b32 v26, 31, v24
    v_lshl_add_u32 v18, v26, 3, v18
    v_lshlrev_b32 v18, 4, v18
    v_lshrrev_b32 v26, 5, v24
    v_xor_b32 v26, s69, v26
    v_xor_b32 v26, 1, v26
    v_lshlrev_b32 v26, 16, v26
    v_add_u32 v18, v18, v26
    v_lshlrev_b32 v19, 16, v25
    v_lshrrev_b32 v26, 2, v24
    v_lshlrev_b32 v26, 4, v26
    v_add_u32 v19, v19, v26
    v_and_b32 v26, 2, v24
    v_lshlrev_b32 v26, 9, v26
    v_add_u32 v19, v19, v26
    v_and_b32 v20, 1, v24
    s_lshl_b32 s89, s62, 19
    s_lshr_b32 s3, s61, 2
    s_lshl_b32 s3, s3, 11
    s_add_u32 s89, s89, s3
    s_and_b32 s3, s61, 3
    s_lshl_b32 s3, s3, 8
    s_add_u32 s89, s89, s3
    s_add_u32 s89, s89, 16777216
    s_lshl_b32 s86, s61, 16
    s_lshl_b32 s87, s62, 7
    s_add_u32 s86, s86, s87
    s_lshl_b32 s88, s61, 11
    s_add_u32 s88, s88, 4194320
    s_mul_i32 s64, s61, 224
    s_add_u32 s64, s64, s79
    s_mul_i32 s3, s69, 112
    s_add_u32 s64, s64, s3
    s_lshl_b32 s64, s64, 10
    s_add_u32 s64, s64, 5242880
    s_lshl_b32 s65, s66, 10
    s_add_u32 s65, s65, s64
    s_add_u32 s67, s64, 16384
    s_mul_i32 s68, s69, 229376
    s_sub_u32 s68, 114688, s68
    v_min_u32 v28, 27, v1
    v_lshlrev_b32 v28, 3, v28
    s_lshl_b32 s78, s61, 8
    s_add_u32 s78, s78, 4349952
    s_cmp_lg_u32 s48, 0
    s_cbranch_scc1 L_np_67
    s_mov_b32 s3, 0
L_spin_68:
    buffer_load_dwordx2 v[8:9], v28, s[4:7], s78 offen sc1
    s_waitcnt vmcnt(0)
    v_xor_b32 v8, s52, v8
    v_xor_b32 v9, s53, v9
    v_or_b32 v8, v8, v9
    v_cmp_ne_u32 vcc, 0, v8
    s_cbranch_vccz L_ok_69
    s_add_u32 s3, s3, 1
    s_cmp_gt_u32 s3, 20000
    s_cbranch_scc1 L_ok_69
    s_sleep 8
    s_branch L_spin_68
L_ok_69:
    v_mov_b32 v8, 1
    s_mov_b64 exec, 1
    ds_write_b32 v31, v8 offset:120
    s_mov_b64 exec, -1
L_np_67:
    s_mov_b32 s3, 0
L_ws_70:
    ds_read_b32 v8, v31 offset:120
    s_waitcnt lgkmcnt(0)
    v_cmp_eq_u32 vcc, 0, v8
    s_cbranch_vccz L_wo_71
    s_add_u32 s3, s3, 1
    s_cmp_gt_u32 s3, 400000
    s_cbranch_scc1 L_wo_71
    s_sleep 1
    s_branch L_ws_70
L_wo_71:
    buffer_load_dwordx4 v[96:99], v13, s[4:7], s65 offen sc1
    s_add_u32 s65, s65, 1024
    s_cmp_eq_u32 s65, s67
    s_cselect_b32 s65, s64, s65
    buffer_load_dwordx4 v[100:103], v13, s[4:7], s65 offen sc1
    s_add_u32 s65, s65, 1024
    s_cmp_eq_u32 s65, s67
    s_cselect_b32 s65, s64, s65
    buffer_load_dwordx4 v[104:107], v13, s[4:7], s65 offen sc1
    s_add_u32 s65, s65, 1024
    s_cmp_eq_u32 s65, s67
    s_cselect_b32 s65, s64, s65
    buffer_load_dwordx4 v[108:111], v13, s[4:7], s65 offen sc1
    s_add_u32 s65, s65, 1024
    s_cmp_eq_u32 s65, s67
    s_cselect_b32 s65, s64, s65
    buffer_load_dwordx4 v[112:115], v13, s[4:7], s65 offen sc1
    s_add_u32 s65, s65, 1024
    s_cmp_eq_u32 s65, s67
    s_cselect_b32 s65, s64, s65
    buffer_load_dwordx4 v[116:119], v13, s[4:7], s65 offen sc1
    s_add_u32 s65, s65, 1024
    s_cmp_eq_u32 s65, s67
    s_cselect_b32 s65, s64, s65
    s_waitcnt vmcnt(5)
    v_mfma_f32_32x32x16_bf16 v[32:47], v[128:131], v[96:99], 0
    v_mfma_f32_32x32x16_bf16 v[48:63], v[132:135], v[96:99], 0
    buffer_load_dwordx4 v[120:123], v13, s[4:7], s65 offen sc1
    s_add_u32 s65, s65, 1024
    s_cmp_eq_u32 s65, s67
    s_cselect_b32 s65, s64, s65
    s_waitcnt vmcnt(5)
    v_mfma_f32_32x32x16_bf16 v[32:47], v[136:139], v[100:103], v[32:47]
    v_mfma_f32_32x32x16_bf16 v[48:63], v[140:143], v[100:103], v[48:63]
    buffer_load_dwordx4 v[124:127], v13, s[4:7], s65 offen sc1
    s_add_u32 s65, s65, 1024
    s_cmp_eq_u32 s65, s67
    s_cselect_b32 s65, s64, s65
    s_waitcnt vmcnt(5)
    v_mfma_f32_32x32x16_bf16 v[32:47], v[144:147], v[104:107], v[32:47]
    v_mfma_f32_32x32x16_bf16 v[48:63], v[148:151], v[104:107], v[48:63]
    buffer_load_dwordx4 v[96:99], v13, s[4:7], s65 offen sc1
    s_add_u32 s65, s65, 1024
    s_cmp_eq_u32 s65, s67
    s_cselect_b32 s65, s64, s65
    s_waitcnt vmcnt(5)
    v_mfma_f32_32x32x16_bf16 v[32:47], v[152:155], v[108:111], v[32:47]
    v_mfma_f32_32x32x16_bf16 v[48:63], v[156:159], v[108:111], v[48:63]
    buffer_load_dwordx4 v[100:103], v13, s[4:7], s65 offen sc1
    s_add_u32 s65, s65, 1024
    s_cmp_eq_u32 s65, s67
    s_cselect_b32 s65, s64, s65
    s_waitcnt vmcnt(5)
    v_mfma_f32_32x32x16_bf16 v[32:47], v[160:163], v[112:115], v[32:47]
    v_mfma_f32_32x32x16_bf16 v[48:63], v[164:167], v[112:115], v[48:63]
    buffer_load_dwordx4 v[104:107], v13, s[4:7], s65 offen sc1
    s_add_u32 s65, s65, 1024
    s_cmp_eq_u32 s65, s67
    s_cselect_b32 s65, s64, s65
    s_waitcnt vmcnt(5)
    v_mfma_f32_32x32x16_bf16 v[32:47], v[168:171], v[116:119], v[32:47]
    v_mfma_f32_32x32x16_bf16 v[48:63], v[172:175], v[116:119], v[48:63]
    buffer_load_dwordx4 v[108:111], v13, s[4:7], s65 offen sc1
    s_add_u32 s65, s65, 1024
    s_cmp_eq_u32 s65, s67
    s_cselect_b32 s65, s64, s65
    s_waitcnt vmcnt(5)
    v_mfma_f32_32x32x16_bf16 v[32:47], v[176:179], v[120:123], v[32:47]
    v_mfma_f32_32x32x16_bf16 v[48:63], v[180:183], v[120:123], v[48:63]
    buffer_load_dwordx4 v[112:115], v13, s[4:7], s65 offen sc1
    s_add_u32 s65, s65, 1024
    s_cmp_eq_u32 s65, s67
    s_cselect_b32 s65, s64, s65
    s_waitcnt vmcnt(5)
    v_mfma_f32_32x32x16_bf16 v[32:47], v[184:187], v[124:127], v[32:47]
    v_mfma_f32_32x32x16_bf16 v[48:63], v[188:191], v[124:127], v[48:63]
    buffer_load_dwordx4 v[116:119], v13, s[4:7], s65 offen sc1
    s_add_u32 s65, s65, 1024
    s_cmp_eq_u32 s65, s67
    s_cselect_b32 s65, s64, s65
    s_waitcnt vmcnt(5)
    v_mfma_f32_32x32x16_bf16 v[32:47], v[192:195], v[96:99], v[32:47]
    v_mfma_f32_32x32x16_bf16 v[48:63], v[196:199], v[96:99], v[48:63]
    buffer_load_dwordx4 v[120:123], v13, s[4:7], s65 offen sc1
    s_add_u32 s65, s65, 1024
    s_cmp_eq_u32 s65, s67
    s_cselect_b32 s65, s64, s65
    s_waitcnt vmcnt(5)
    v_mfma_f32_32x32x16_bf16 v[32:47], v[200:203], v[100:103], v[32:47]
    v_mfma_f32_32x32x16_bf16 v[48:63], v[204:207], v[100:103], v[48:63]
    buffer_load_dwordx4 v[124:127], v13, s[4:7], s65 offen sc1
    s_add_u32 s65, s65, 1024
    s_cmp_eq_u32 s65, s67
    s_cselect_b32 s65, s64, s65
    s_add_u32 s65, s65, s68
    s_add_u32 s67, s67, s68
    s_add_u32 s64, s64, s68
    s_waitcnt vmcnt(5)
    v_mfma_f32_32x32x16_bf16 v[32:47], v[208:211], v[104:107], v[32:47]
    v_mfma_f32_32x32x16_bf16 v[48:63], v[212:215], v[104:107], v[48:63]
    buffer_load_dwordx4 v[96:99], v13, s[4:7], s65 offen sc1
    s_add_u32 s65, s65, 1024
    s_cmp_eq_u32 s65, s67
    s_cselect_b32 s65, s64, s65
    s_waitcnt vmcnt(5)
    v_mfma_f32_32x32x16_bf16 v[32:47], v[216:219], v[108:111], v[32:47]
    v_mfma_f32_32x32x16_bf16 v[48:63], v[220:223], v[108:111], v[48:63]
    buffer_load_dwordx4 v[100:103], v13, s[4:7], s65 offen sc1
    s_add_u32 s65, s65, 1024
    s_cmp_eq_u32 s65, s67
    s_cselect_b32 s65, s64, s65
    s_waitcnt vmcnt(5)
    v_mfma_f32_32x32x16_bf16 v[32:47], v[224:227], v[112:115], v[32:47]
    v_mfma_f32_32x32x16_bf16 v[48:63], v[228:231], v[112:115], v[48:63]
    buffer_load_dwordx4 v[104:107], v13, s[4:7], s65 offen sc1
    s_add_u32 s65, s65, 1024
    s_cmp_eq_u32 s65, s67
    s_cselect_b32 s65, s64, s65
    s_waitcnt vmcnt(5)
    v_mfma_f32_32x32x16_bf16 v[32:47], v[232:235], v[116:119], v[32:47]
    v_mfma_f32_32x32x16_bf16 v[48:63], v[236:239], v[116:119], v[48:63]
    buffer_load_dwordx4 v[108:111], v13, s[4:7], s65 offen sc1
    s_add_u32 s65, s65, 1024
    s_cmp_eq_u32 s65, s67
    s_cselect_b32 s65, s64, s65
    s_waitcnt vmcnt(5)
    v_mfma_f32_32x32x16_bf16 v[32:47], v[240:243], v[120:123], v[32:47]
    v_mfma_f32_32x32x16_bf16 v[48:63], v[244:247], v[120:123], v[48:63]
    buffer_load_dwordx4 v[112:115], v13, s[4:7], s65 offen sc1
    s_add_u32 s65, s65, 1024
    s_cmp_eq_u32 s65, s67
    s_cselect_b32 s65, s64, s65
    s_waitcnt vmcnt(5)
    v_mfma_f32_32x32x16_bf16 v[32:47], v[248:251], v[124:127], v[32:47]
    v_mfma_f32_32x32x16_bf16 v[48:63], v[252:255], v[124:127], v[48:63]
    buffer_load_dwordx4 v[116:119], v13, s[4:7], s65 offen sc1
    s_add_u32 s65, s65, 1024
    s_cmp_eq_u32 s65, s67
    s_cselect_b32 s65, s64, s65
    s_mov_b32 s3, 0
L_fs_72:
    ds_read_b128 v[24:27], v31 offset:48
    s_waitcnt lgkmcnt(0)
    v_min3_u32 v24, v24, v25, v26
    v_min_u32 v24, v24, v27
    v_cmp_gt_u32 vcc, 1, v24
    s_cbranch_vccz L_fo_73
    s_add_u32 s3, s3, 1
    s_cmp_gt_u32 s3, 400000
    s_cbranch_scc1 L_fo_73
    s_sleep 1
    s_branch L_fs_72
L_fo_73:
    s_waitcnt vmcnt(5)
    v_mfma_f32_32x32x16_bf16 v[64:79], v[128:131], v[96:99], 0
    v_mfma_f32_32x32x16_bf16 v[80:95], v[132:135], v[96:99], 0
    buffer_load_dwordx4 v[120:123], v13, s[4:7], s65 offen sc1
    s_add_u32 s65, s65, 1024
    s_cmp_eq_u32 s65, s67
    s_cselect_b32 s65, s64, s65
    s_waitcnt vmcnt(5)
    v_mfma_f32_32x32x16_bf16 v[64:79], v[136:139], v[100:103], v[64:79]
    v_mfma_f32_32x32x16_bf16 v[80:95], v[140:143], v[100:103], v[80:95]
    buffer_load_dwordx4 v[124:127], v13, s[4:7], s65 offen sc1
    s_add_u32 s65, s65, 1024
    s_cmp_eq_u32 s65, s67
    s_cselect_b32 s65, s64, s65
    ds_write_b128 v14, v[32:35] offset:0
    s_waitcnt vmcnt(5)
    v_mfma_f32_32x32x16_bf16 v[64:79], v[144:147], v[104:107], v[64:79]
    v_mfma_f32_32x32x16_bf16 v[80:95], v[148:151], v[104:107], v[80:95]
    buffer_load_dwordx4 v[96:99], v13, s[4:7], s65 offen sc1
    s_add_u32 s65, s65, 1024
    s_cmp_eq_u32 s65, s67
    s_cselect_b32 s65, s64, s65
    ds_write_b128 v15, v[36:39] offset:0
    s_waitcnt vmcnt(5)
    v_mfma_f32_32x32x16_bf16 v[64:79], v[152:155], v[108:111], v[64:79]
    v_mfma_f32_32x32x16_bf16 v[80:95], v[156:159], v[108:111], v[80:95]
    buffer_load_dwordx4 v[100:103], v13, s[4:7], s65 offen sc1
    s_add_u32 s65, s65, 1024
    s_cmp_eq_u32 s65, s67
    s_cselect_b32 s65, s64, s65
    ds_write_b128 v16, v[40:43] offset:0
    buffer_load_dwordx4 v[128:131], v21, s[8:11], s86 offen
    buffer_load_dwordx4 v[132:135], v22, s[44:47], s87 offen
    buffer_load_dwordx4 v[136:139], v23, s[4:7], s88 offen sc1
    s_waitcnt vmcnt(8)
    v_mfma_f32_32x32x16_bf16 v[64:79], v[160:163], v[112:115], v[64:79]
    v_mfma_f32_32x32x16_bf16 v[80:95], v[164:167], v[112:115], v[80:95]
    buffer_load_dwordx4 v[104:107], v13, s[4:7], s65 offen sc1
    s_add_u32 s65, s65, 1024
    s_cmp_eq_u32 s65, s67
    s_cselect_b32 s65, s64, s65
    ds_write_b128 v17, v[44:47] offset:0
    s_waitcnt vmcnt(8)
    v_mfma_f32_32x32x16_bf16 v[64:79], v[168:171], v[116:119], v[64:79]
    v_mfma_f32_32x32x16_bf16 v[80:95], v[172:175], v[116:119], v[80:95]
    buffer_load_dwordx4 v[108:111], v13, s[4:7], s65 offen sc1
    s_add_u32 s65, s65, 1024
    s_cmp_eq_u32 s65, s67
    s_cselect_b32 s65, s64, s65
    ds_write_b128 v14, v[48:51] offset:4096
    s_waitcnt vmcnt(8)
    v_mfma_f32_32x32x16_bf16 v[64:79], v[176:179], v[120:123], v[64:79]
    v_mfma_f32_32x32x16_bf16 v[80:95], v[180:183], v[120:123], v[80:95]
    buffer_load_dwordx4 v[112:115], v13, s[4:7], s65 offen sc1
    s_add_u32 s65, s65, 1024
    s_cmp_eq_u32 s65, s67
    s_cselect_b32 s65, s64, s65
    ds_write_b128 v15, v[52:55] offset:4096
    s_waitcnt vmcnt(8)
    v_mfma_f32_32x32x16_bf16 v[64:79], v[184:187], v[124:127], v[64:79]
    v_mfma_f32_32x32x16_bf16 v[80:95], v[188:191], v[124:127], v[80:95]
    buffer_load_dwordx4 v[116:119], v13, s[4:7], s65 offen sc1
    s_add_u32 s65, s65, 1024
    s_cmp_eq_u32 s65, s67
    s_cselect_b32 s65, s64, s65
    ds_write_b128 v16, v[56:59] offset:4096
    s_waitcnt vmcnt(8)
    v_mfma_f32_32x32x16_bf16 v[64:79], v[192:195], v[96:99], v[64:79]
    v_mfma_f32_32x32x16_bf16 v[80:95], v[196:199], v[96:99], v[80:95]
    buffer_load_dwordx4 v[120:123], v13, s[4:7], s65 offen sc1
    s_add_u32 s65, s65, 1024
    s_cmp_eq_u32 s65, s67
    s_cselect_b32 s65, s64, s65
    ds_write_b128 v17, v[60:63] offset:4096
    s_waitcnt vmcnt(8)
    v_mfma_f32_32x32x16_bf16 v[64:79], v[200:203], v[100:103], v[64:79]
    v_mfma_f32_32x32x16_bf16 v[80:95], v[204:207], v[100:103], v[80:95]
    buffer_load_dwordx4 v[124:127], v13, s[4:7], s65 offen sc1
    s_add_u32 s65, s65, 1024
    s_cmp_eq_u32 s65, s67
    s_cselect_b32 s65, s64, s65
    s_waitcnt vmcnt(5)
    v_mfma_f32_32x32x16_bf16 v[64:79], v[208:211], v[104:107], v[64:79]
    v_mfma_f32_32x32x16_bf16 v[80:95], v[212:215], v[104:107], v[80:95]
    s_waitcnt vmcnt(4)
    v_mfma_f32_32x32x16_bf16 v[64:79], v[216:219], v[108:111], v[64:79]
    v_mfma_f32_32x32x16_bf16 v[80:95], v[220:223], v[108:111], v[80:95]
    s_waitcnt vmcnt(6)
    s_mov_b32 s3, 0
L_spin_74:
    v_xor_b32 v137, s52, v137
    v_xor_b32 v139, s53, v139
    v_or_b32 v137, v137, v139
    v_cmp_ne_u32 vcc, 0, v137
    s_cbranch_vccz L_ok_75
    s_add_u32 s3, s3, 1
    s_cmp_gt_u32 s3, 20000
    s_cbranch_scc1 L_ok_75
    s_sleep 2
    buffer_load_dwordx4 v[136:139], v23, s[4:7], s88 offen sc1
    s_waitcnt vmcnt(0)
    s_branch L_spin_74
L_ok_75:
    s_waitcnt vmcnt(3)
    v_mfma_f32_32x32x16_bf16 v[64:79], v[224:227], v[112:115], v[64:79]
    v_lshlrev_b32 v152, 16, v128
    v_and_b32 v153, s51, v128
    v_lshlrev_b32 v168, 16, v132
    v_and_b32 v169, s51, v132
    v_lshlrev_b32 v154, 16, v129
    v_and_b32 v155, s51, v129
    v_lshlrev_b32 v170, 16, v133
    v_mfma_f32_32x32x16_bf16 v[80:95], v[228:231], v[112:115], v[80:95]
    v_and_b32 v171, s51, v133
    v_lshlrev_b32 v156, 16, v130
    v_and_b32 v157, s51, v130
    v_lshlrev_b32 v172, 16, v134
    v_and_b32 v173, s51, v134
    v_lshlrev_b32 v158, 16, v131
    v_and_b32 v159, s51, v131
    s_waitcnt vmcnt(2)
    v_mfma_f32_32x32x16_bf16 v[64:79], v[232:235], v[116:119], v[64:79]
    v_lshlrev_b32 v174, 16, v135
    v_and_b32 v175, s51, v135
    v_sub_f32 v160, v152, v136
    v_sub_f32 v161, v153, v136
    v_sub_f32 v162, v154, v136
    v_sub_f32 v163, v155, v136
    v_sub_f32 v164, v156, v136
    v_mfma_f32_32x32x16_bf16 v[80:95], v[236:239], v[116:119], v[80:95]
    v_sub_f32 v165, v157, v136
    v_sub_f32 v166, v158, v136
    v_sub_f32 v167, v159, v136
    v_cvt_pk_bf16_f32 v148, v160, v161
    v_cvt_pk_bf16_f32 v149, v162, v163
    v_cvt_pk_bf16_f32 v150, v164, v165
    v_cvt_pk_bf16_f32 v151, v166, v167
    s_waitcnt vmcnt(1)
    v_mfma_f32_32x32x16_bf16 v[64:79], v[240:243], v[120:123], v[64:79]
    v_lshlrev_b32 v160, 16, v148
    v_and_b32 v161, s51, v148
    v_lshlrev_b32 v162, 16, v149
    v_and_b32 v163, s51, v149
    v_lshlrev_b32 v164, 16, v150
    v_and_b32 v165, s51, v150
    v_lshlrev_b32 v166, 16, v151
    v_mfma_f32_32x32x16_bf16 v[80:95], v[244:247], v[120:123], v[80:95]
    v_and_b32 v167, s51, v151
    v_mul_f32 v160, v160, v138
    v_mul_f32 v161, v161, v138
    v_mul_f32 v162, v162, v138
    v_mul_f32 v163, v163, v138
    v_mul_f32 v164, v164, v138
    v_mul_f32 v165, v165, v138
    s_waitcnt vmcnt(0)
    v_mfma_f32_32x32x16_bf16 v[64:79], v[248:251], v[124:127], v[64:79]
    v_mul_f32 v166, v166, v138
    v_mul_f32 v167, v167, v138
    v_cvt_pk_bf16_f32 v148, v160, v161
    v_cvt_pk_bf16_f32 v149, v162, v163
    v_cvt_pk_bf16_f32 v150, v164, v165
    v_cvt_pk_bf16_f32 v151, v166, v167
    v_lshlrev_b32 v160, 16, v148
    v_mfma_f32_32x32x16_bf16 v[80:95], v[252:255], v[124:127], v[80:95]
    v_and_b32 v161, s51, v148
    v_lshlrev_b32 v162, 16, v149
    v_and_b32 v163, s51, v149
    v_lshlrev_b32 v164, 16, v150
    v_and_b32 v165, s51, v150
    v_lshlrev_b32 v166, 16, v151
    v_and_b32 v167, s51, v151
    s_add_u32 s3, s89, 0
    buffer_load_dwordx4 v[176:179], v19, s[4:7], s3 offen sc1
    s_add_u32 s3, s89, 16384
    buffer_load_dwordx4 v[180:183], v19, s[4:7], s3 offen sc1
    s_add_u32 s3, s89, 32768
    buffer_load_dwordx4 v[184:187], v19, s[4:7], s3 offen sc1
    s_add_u32 s3, s89, 49152
    buffer_load_dwordx4 v[188:191], v19, s[4:7], s3 offen sc1
    v_xor_b32 v14, 0x18000, v14
    v_xor_b32 v15, 0x18000, v15
    v_xor_b32 v16, 0x18000, v16
    v_xor_b32 v17, 0x18000, v17
    s_mov_b32 s3, 0
L_fs_76:
    ds_read_b128 v[24:27], v31 offset:96
    s_waitcnt lgkmcnt(0)
    v_min3_u32 v24, v24, v25, v26
    v_min_u32 v24, v24, v27
    v_cmp_gt_u32 vcc, 1, v24
    s_cbranch_vccz L_fo_77
    s_add_u32 s3, s3, 1
    s_cmp_gt_u32 s3, 400000
    s_cbranch_scc1 L_fo_77
    s_sleep 1
    s_branch L_fs_76
L_fo_77:
    s_nop 0
    ds_write_b128 v14, v[64:67] offset:0
    ds_write_b128 v15, v[68:71] offset:0
    ds_write_b128 v16, v[72:75] offset:0
    ds_write_b128 v17, v[76:79] offset:0
    ds_write_b128 v14, v[80:83] offset:4096
    ds_write_b128 v15, v[84:87] offset:4096
    ds_write_b128 v16, v[88:91] offset:4096
    ds_write_b128 v17, v[92:95] offset:4096
L_join:
    s_cmp_lg_u32 s2, 255
    s_cbranch_scc1 L_noep_78
    s_cmp_lg_u32 s48, 0
    s_cbranch_scc1 L_noep_78
    v_lshlrev_b32 v3, 14, v1
    s_mov_b32 s76, 0
L_spin_79:
    s_nop 0
    s_mov_b32 s3, 16777216
    buffer_load_dwordx4 v[96:99], v3, s[4:7], s3 offen sc1
    s_mov_b32 s3, 17825792
    buffer_load_dwordx4 v[100:103], v3, s[4:7], s3 offen sc1
    s_mov_b32 s3, 18874368
    buffer_load_dwordx4 v[104:107], v3, s[4:7], s3 offen sc1
    s_mov_b32 s3, 19922944
    buffer_load_dwordx4 v[108:111], v3, s[4:7], s3 offen sc1
    s_waitcnt vmcnt(0)
    v_xor_b32 v97, s52, v97
    v_xor_b32 v99, s53, v99
    v_xor_b32 v101, s52, v101
    v_xor_b32 v103, s53, v103
    v_xor_b32 v105, s52, v105
    v_xor_b32 v107, s53, v107
    v_xor_b32 v109, s52, v109
    v_xor_b32 v111, s53, v111
    v_or3_b32 v97, v97, v99, v101
    v_or3_b32 v103, v103, v105, v107
    v_or3_b32 v97, v97, v109, v111
    v_or_b32 v97, v97, v103
    v_cmp_ne_u32 vcc, 0, v97
    s_cbranch_vccz L_ok_80
    s_add_u32 s76, s76, 1
    s_cmp_gt_u32 s76, 20000
    s_cbranch_scc1 L_ok_80
    s_sleep 8
    s_branch L_spin_79
L_ok_80:
    v_mov_b32 v96, s52
    v_mov_b32 v97, 0
    s_mov_b32 s76, 4325376
    s_mov_b64 exec, 1
    buffer_store_dword v96, v97, s[4:7], s76 offen sc1
    s_mov_b64 exec, -1
L_noep_78:
    s_waitcnt lgkmcnt(0)
    s_barrier
    ds_read_b128 v[64:67], v18 offset:0
    ds_read_b128 v[68:71], v18 offset:4096
    ds_read_b128 v[72:75], v18 offset:8192
    ds_read_b128 v[76:79], v18 offset:12288
    ds_read_b128 v[80:83], v18 offset:16384
    ds_read_b128 v[84:87], v18 offset:20480
    ds_read_b128 v[88:91], v18 offset:24576
    ds_read_b128 v[92:95], v18 offset:28672
    ds_read_b128 v[96:99], v18 offset:32768
    ds_read_b128 v[100:103], v18 offset:36864
    ds_read_b128 v[104:107], v18 offset:40960
    ds_read_b128 v[108:111], v18 offset:45056
    ds_read_b128 v[112:115], v18 offset:49152
    ds_read_b128 v[116:119], v18 offset:53248
    ds_read_b128 v[120:123], v18 offset:57344
    ds_read_b128 v[124:127], v18 offset:61440
    s_waitcnt lgkmcnt(12)
    v_pk_add_f32 v[64:65], v[64:65], v[72:73]
    v_pk_add_f32 v[66:67], v[66:67], v[74:75]
    v_pk_add_f32 v[68:69], v[68:69], v[76:77]
    v_pk_add_f32 v[70:71], v[70:71], v[78:79]
    s_waitcnt lgkmcnt(10)
    v_pk_add_f32 v[64:65], v[64:65], v[80:81]
    v_pk_add_f32 v[66:67], v[66:67], v[82:83]
    v_pk_add_f32 v[68:69], v[68:69], v[84:85]
    v_pk_add_f32 v[70:71], v[70:71], v[86:87]
    s_waitcnt lgkmcnt(8)
    v_pk_add_f32 v[64:65], v[64:65], v[88:89]
    v_pk_add_f32 v[66:67], v[66:67], v[90:91]
    v_pk_add_f32 v[68:69], v[68:69], v[92:93]
    v_pk_add_f32 v[70:71], v[70:71], v[94:95]
    s_waitcnt lgkmcnt(6)
    v_pk_add_f32 v[64:65], v[64:65], v[96:97]
    v_pk_add_f32 v[66:67], v[66:67], v[98:99]
    v_pk_add_f32 v[68:69], v[68:69], v[100:101]
    v_pk_add_f32 v[70:71], v[70:71], v[102:103]
    s_waitcnt lgkmcnt(4)
    v_pk_add_f32 v[64:65], v[64:65], v[104:105]
    v_pk_add_f32 v[66:67], v[66:67], v[106:107]
    v_pk_add_f32 v[68:69], v[68:69], v[108:109]
    v_pk_add_f32 v[70:71], v[70:71], v[110:111]
    s_waitcnt lgkmcnt(2)
    v_pk_add_f32 v[64:65], v[64:65], v[112:113]
    v_pk_add_f32 v[66:67], v[66:67], v[114:115]
    v_pk_add_f32 v[68:69], v[68:69], v[116:117]
    v_pk_add_f32 v[70:71], v[70:71], v[118:119]
    s_waitcnt lgkmcnt(0)
    s_nop 0
    v_pk_add_f32 v[64:65], v[64:65], v[120:121]
    v_pk_add_f32 v[66:67], v[66:67], v[122:123]
    v_pk_add_f32 v[68:69], v[68:69], v[124:125]
    v_pk_add_f32 v[70:71], v[70:71], v[126:127]
    v_cvt_pk_bf16_f32 v148, v64, v68
    v_cvt_pk_bf16_f32 v149, v65, v69
    v_cvt_pk_bf16_f32 v150, v66, v70
    v_cvt_pk_bf16_f32 v151, v67, v71
    v_lshlrev_b32 v32, 16, v148
    v_and_b32 v33, s51, v148
    v_lshlrev_b32 v34, 16, v149
    v_and_b32 v35, s51, v149
    v_lshlrev_b32 v36, 16, v150
    v_and_b32 v37, s51, v150
    v_lshlrev_b32 v38, 16, v151
    v_and_b32 v39, s51, v151
    v_pk_add_f32 v[32:33], v[32:33], v[168:169]
    v_pk_add_f32 v[34:35], v[34:35], v[170:171]
    v_pk_add_f32 v[36:37], v[36:37], v[172:173]
    v_pk_add_f32 v[38:39], v[38:39], v[174:175]
    v_cvt_pk_bf16_f32 v148, v32, v33
    v_cvt_pk_bf16_f32 v149, v34, v35
    v_cvt_pk_bf16_f32 v150, v36, v37
    v_cvt_pk_bf16_f32 v151, v38, v39
    v_lshlrev_b32 v32, 16, v148
    v_and_b32 v33, s51, v148
    v_lshlrev_b32 v34, 16, v149
    v_and_b32 v35, s51, v149
    v_lshlrev_b32 v36, 16, v150
    v_and_b32 v37, s51, v150
    v_lshlrev_b32 v38, 16, v151
    v_and_b32 v39, s51, v151
    v_mul_f32 v48, 0xbfb8aa3b, v32
    v_mul_f32 v49, 0xbfb8aa3b, v33
    v_mul_f32 v50, 0xbfb8aa3b, v34
    v_mul_f32 v51, 0xbfb8aa3b, v35
    v_mul_f32 v52, 0xbfb8aa3b, v36
    v_mul_f32 v53, 0xbfb8aa3b, v37
    v_mul_f32 v54, 0xbfb8aa3b, v38
    v_mul_f32 v55, 0xbfb8aa3b, v39
    v_exp_f32 v48, v48
    v_exp_f32 v49, v49
    v_exp_f32 v50, v50
    v_exp_f32 v51, v51
    v_exp_f32 v52, v52
    v_exp_f32 v53, v53
    v_exp_f32 v54, v54
    v_exp_f32 v55, v55
    v_add_f32 v48, 1.0, v48
    v_add_f32 v49, 1.0, v49
    v_add_f32 v50, 1.0, v50
    v_add_f32 v51, 1.0, v51
    v_add_f32 v52, 1.0, v52
    v_add_f32 v53, 1.0, v53
    v_add_f32 v54, 1.0, v54
    v_add_f32 v55, 1.0, v55
    v_rcp_f32 v48, v48
    v_rcp_f32 v49, v49
    v_rcp_f32 v50, v50
    v_rcp_f32 v51, v51
    v_rcp_f32 v52, v52
    v_rcp_f32 v53, v53
    v_rcp_f32 v54, v54
    v_rcp_f32 v55, v55
    v_pk_mul_f32 v[32:33], v[32:33], v[48:49]
    v_pk_mul_f32 v[34:35], v[34:35], v[50:51]
    v_pk_mul_f32 v[36:37], v[36:37], v[52:53]
    v_pk_mul_f32 v[38:39], v[38:39], v[54:55]
    v_cvt_pk_bf16_f32 v148, v32, v33
    v_cvt_pk_bf16_f32 v149, v34, v35
    v_cvt_pk_bf16_f32 v150, v36, v37
    v_cvt_pk_bf16_f32 v151, v38, v39
    v_lshlrev_b32 v32, 16, v148
    v_and_b32 v33, s51, v148
    v_lshlrev_b32 v34, 16, v149
    v_and_b32 v35, s51, v149
    v_lshlrev_b32 v36, 16, v150
    v_and_b32 v37, s51, v150
    v_lshlrev_b32 v38, 16, v151
    v_and_b32 v39, s51, v151
    s_mov_b32 s76, 0
L_spin_81:
    s_waitcnt vmcnt(0)
    v_xor_b32 v177, s52, v177
    v_xor_b32 v179, s53, v179
    v_xor_b32 v181, s52, v181
    v_xor_b32 v183, s53, v183
    v_xor_b32 v185, s52, v185
    v_xor_b32 v187, s53, v187
    v_xor_b32 v189, s52, v189
    v_xor_b32 v191, s53, v191
    v_or3_b32 v56, v177, v179, v181
    v_or3_b32 v57, v183, v185, v187
    v_or3_b32 v56, v56, v189, v191
    v_or_b32 v56, v56, v57
    v_cmp_ne_u32 vcc, 0, v56
    s_cbranch_vccz L_ok_82
    s_add_u32 s76, s76, 1
    s_cmp_gt_u32 s76, 20000
    s_cbranch_scc1 L_ok_82
    s_sleep 4
    s_add_u32 s3, s89, 0
    s_nop 0
    buffer_load_dwordx4 v[176:179], v19, s[4:7], s3 offen sc1
    s_add_u32 s3, s89, 16384
    buffer_load_dwordx4 v[180:183], v19, s[4:7], s3 offen sc1
    s_add_u32 s3, s89, 32768
    buffer_load_dwordx4 v[184:187], v19, s[4:7], s3 offen sc1
    s_add_u32 s3, s89, 49152
    buffer_load_dwordx4 v[188:191], v19, s[4:7], s3 offen sc1
    s_branch L_spin_81
L_ok_82:
    v_cmp_eq_u32 vcc, 1, v20
    s_nop 1
    v_cndmask_b32 v176, v176, v178, vcc
    v_cndmask_b32 v180, v180, v182, vcc
    v_cndmask_b32 v184, v184, v186, vcc
    v_cndmask_b32 v188, v188, v190, vcc
    v_lshlrev_b32 v40, 16, v176
    v_and_b32 v41, s51, v176
    v_lshlrev_b32 v42, 16, v180
    v_and_b32 v43, s51, v180
    v_lshlrev_b32 v44, 16, v184
    v_and_b32 v45, s51, v184
    v_lshlrev_b32 v46, 16, v188
    v_and_b32_e64 v47, s51, v188
    v_pk_mul_f32 v[160:161], v[160:161], v[40:41]
    v_pk_mul_f32 v[162:163], v[162:163], v[42:43]
    v_pk_mul_f32 v[164:165], v[164:165], v[44:45]
    v_pk_mul_f32 v[166:167], v[166:167], v[46:47]
    v_cvt_pk_bf16_f32 v148, v160, v161
    v_cvt_pk_bf16_f32 v149, v162, v163
    v_cvt_pk_bf16_f32 v150, v164, v165
    v_cvt_pk_bf16_f32 v151, v166, v167
    v_lshlrev_b32 v160, 16, v148
    v_and_b32 v161, s51, v148
    v_lshlrev_b32 v162, 16, v149
    v_and_b32 v163, s51, v149
    v_lshlrev_b32 v164, 16, v150
    v_and_b32 v165, s51, v150
    v_lshlrev_b32 v166, 16, v151
    v_and_b32 v167, s51, v151
    v_pk_mul_f32 v[160:161], v[160:161], v[32:33]
    v_pk_mul_f32 v[162:163], v[162:163], v[34:35]
    v_pk_mul_f32 v[164:165], v[164:165], v[36:37]
    v_pk_mul_f32 v[166:167], v[166:167], v[38:39]
    v_cvt_pk_bf16_f32 v148, v160, v161
    v_cvt_pk_bf16_f32 v149, v162, v163
    v_cvt_pk_bf16_f32 v150, v164, v165
    v_cvt_pk_bf16_f32 v151, v166, v167
    v_lshlrev_b32 v160, 16, v148
    v_and_b32 v161, s51, v148
    v_lshlrev_b32 v162, 16, v149
    v_and_b32 v163, s51, v149
    v_lshlrev_b32 v164, 16, v150
    v_and_b32 v165, s51, v150
    v_lshlrev_b32 v166, 16, v151
    v_and_b32 v167, s51, v151
    v_pk_add_f32 v[160:161], v[160:161], v[152:153]
    v_pk_add_f32 v[162:163], v[162:163], v[154:155]
    v_pk_add_f32 v[164:165], v[164:165], v[156:157]
    v_pk_add_f32 v[166:167], v[166:167], v[158:159]
    v_cvt_pk_bf16_f32 v148, v160, v161
    v_cvt_pk_bf16_f32 v149, v162, v163
    v_cvt_pk_bf16_f32 v150, v164, v165
    v_cvt_pk_bf16_f32 v151, v166, v167
    buffer_store_dwordx4 v[148:151], v21, s[36:39], s86 offen nt
L_end:
    s_endpgm
L_code_end:
.section .rodata,"a"
.p2align 6
.amdhsa_kernel recurrent_scan__ssm_conv_h3__mixer_channel_mlp__prompt_kernel
  .amdhsa_next_free_vgpr 256
  .amdhsa_next_free_sgpr 102
  .amdhsa_accum_offset 256
  .amdhsa_group_segment_fixed_size 0
  .amdhsa_kernarg_size 112
  .amdhsa_user_sgpr_count 2
  .amdhsa_user_sgpr_kernarg_segment_ptr 1
  .amdhsa_system_sgpr_workgroup_id_x 1
.end_amdhsa_kernel
```
